```python
import torch

def _softmax(x, axis=-1):
    return torch.softmax(x, dim=axis)
def _gelu(x):
    return torch.nn.functional.gelu(x, approximate="tanh")
def _silu(x):
    return torch.nn.functional.silu(x)
def _sigmoid(x):
    return torch.sigmoid(x)
def _layernorm(x, axis=-1, eps=1e-5):
    m = x.mean(dim=axis, keepdim=True)
    v = x.var(dim=axis, keepdim=True, unbiased=False)
    return (x - m) / torch.sqrt(v + eps)
def _scatter_add(tgt, idx, src, axis=0):
    return tgt.clone().index_add_(axis, idx, src)
def _segment_sum(src, seg, n):
    out = torch.zeros((n,) + src.shape[1:], dtype=src.dtype)
    return out.index_add_(0, seg, src)
def _pad(x, pw):
    flat = tuple(v for pair in reversed(pw) for v in pair)
    return torch.nn.functional.pad(x, flat)

kernel_name = 'recurrent_scan__ssm_conv_s5__dense_activation_gelu__prompt'

def setup_inputs():

    _w = (lambda a: (lambda t: t.to(torch.bfloat16) if t.is_floating_point() else t)(torch.as_tensor(a)))
    def _A_setup():
        B, S, D = 1, 2048, 640
        P = D
        Lambda_re = -0.5 * (lambda _x: torch.exp(torch.as_tensor(_x)))((lambda *s: torch.randn(*s, dtype=torch.bfloat16) * 0.4)(P))
        Lambda_im = (lambda *s: torch.randn(*s, dtype=torch.bfloat16) * 0.8)(P) * 1.0
        B_re = (lambda *s: torch.randn(*s, dtype=torch.bfloat16) * 0.8)(P, D) * (D ** -0.5)
        B_im = (lambda *s: torch.randn(*s, dtype=torch.bfloat16) * 0.8)(P, D) * (D ** -0.5)
        C_re = (lambda *s: torch.randn(*s, dtype=torch.bfloat16) * 0.4)(D, P) * (P ** -0.5)
        C_im = (lambda *s: torch.randn(*s, dtype=torch.bfloat16) * 0.8)(D, P) * (P ** -0.5)
        log_dt = (lambda *s: torch.randn(*s, dtype=torch.bfloat16) * 0.4)(P) * 0.3 - 2.0
        Dskip = (lambda *s: torch.randn(*s, dtype=torch.bfloat16) * 0.2)(D)
        return {
            "x": _w((lambda *s: torch.randn(*s, dtype=torch.bfloat16) * 0.05)(B, S, D)),
            "Lambda_re": _w(Lambda_re),
            "Lambda_im": _w(Lambda_im),
            "B_re": _w(B_re),
            "B_im": _w(B_im),
            "C_re": _w(C_re),
            "C_im": _w(C_im),
            "log_dt": _w(log_dt),
            "Dskip": _w(Dskip),
        }
    _A_in = _A_setup()

    def _B_setup():
        B, S, D, F = 1, 2048, 640, 1536
        return {
            "x": _w((lambda *s: torch.randn(*s, dtype=torch.bfloat16) * 0.05)(B, S, D)),
            "w1": _w((lambda *s: torch.randn(*s, dtype=torch.bfloat16) * 0.8)(D, F) * (D ** -0.5)),
            "b1": _w((lambda *s: torch.randn(*s, dtype=torch.bfloat16) * 12.8)(F) * 0.01),
            "w2": _w((lambda *s: torch.randn(*s, dtype=torch.bfloat16) * 1.6)(F, D) * (F ** -0.5)),
            "b2": _w((lambda *s: torch.randn(*s, dtype=torch.bfloat16) * 12.8)(D) * 0.01),
        }
    _B_in = _B_setup()

    return {
        "A_x": _A_in["x"],
        "A_Lambda_re": _A_in["Lambda_re"],
        "A_Lambda_im": _A_in["Lambda_im"],
        "A_B_re": _A_in["B_re"],
        "A_B_im": _A_in["B_im"],
        "A_C_re": _A_in["C_re"],
        "A_C_im": _A_in["C_im"],
        "A_log_dt": _A_in["log_dt"],
        "A_Dskip": _A_in["Dskip"],
        "B_x": _B_in["x"],
        "B_w1": _B_in["w1"],
        "B_b1": _B_in["b1"],
        "B_w2": _B_in["w2"],
        "B_b2": _B_in["b2"],
    }

def reference(A_x, A_Lambda_re, A_Lambda_im, A_B_re, A_B_im, A_C_re, A_C_im, A_log_dt, A_Dskip, B_x, B_w1, B_b1, B_w2, B_b2):
    def _A_ref(x, Lambda_re, Lambda_im, B_re, B_im, C_re, C_im, log_dt, Dskip):
        Bsz, L, H = x.shape
        Lam = Lambda_re + 1j * Lambda_im
        Bmat = B_re + 1j * B_im
        Cmat = C_re + 1j * C_im
        dt = torch.exp(log_dt)
        Lam_bar = torch.exp(dt * Lam)
        B_bar = ((Lam_bar - 1.0) / Lam)[:, None] * Bmat
        Bu = torch.einsum("bld,pd->blp", x + 0j, B_bar)
        h = torch.zeros_like(Bu[:, 0, :])
        hs = []
        for t in range(L):
            h = Lam_bar[None, :] * h + Bu[:, t, :]
            hs.append(h)
        hseq = torch.stack(hs, 1)
        y = 2.0 * torch.einsum("blp,dp->bld", hseq, Cmat).real + x * Dskip[None, None, :]
        return y

    def _B_ref(x, w1, b1, w2, b2):
        h = torch.einsum("bsd,df->bsf", x, w1) + b1
        h = _gelu(h)
        return torch.einsum("bsf,fd->bsd", h, w2) + b2

    x = A_x
    xn = _layernorm(x, axis=-1)
    s = _A_ref(xn, A_Lambda_re, A_Lambda_im, A_B_re, A_B_im, A_C_re, A_C_im, A_log_dt, A_Dskip)
    g = _silu(_B_ref(xn, B_w1, B_b1, B_w2, B_b2))
    return x + s * g
```

```asm
; @launch kernel=kf_kernel grid=(256,1,1) block=(512,1,1) lds=163840
.amdgcn_target "amdgcn-amd-amdhsa--gfx950"
.text
.globl kf_kernel
.p2align 8
.type kf_kernel,@function
kf_kernel:
    s_cmp_ge_u32 s2, 256
    s_cbranch_scc1 L_kf_kernel_end
    s_load_dwordx16 s[4:19], s[0:1], 0
    s_load_dwordx4 s[20:23], s[0:1], 80
    s_load_dwordx2 s[24:25], s[0:1], 96
    s_load_dwordx4 s[28:31], s[0:1], 120
    s_and_b32 s36, s2, 7
    s_lshr_b32 s37, s2, 3
    s_and_b32 s32, s36, 1
    s_lshl_b32 s32, s32, 3
    s_and_b32 s38, s37, 7
    s_add_u32 s32, s32, s38
    s_lshr_b32 s33, s36, 1
    s_lshl_b32 s33, s33, 2
    s_lshr_b32 s38, s37, 3
    s_add_u32 s33, s33, s38
    s_add_u32 s26, s33, s32
    s_and_b32 s26, s26, 1
    s_lshl_b32 s26, s26, 1
    v_lshrrev_b32 v1, 6, v0
    v_and_b32 v0, 63, v0
    v_readfirstlane_b32 s34, v1
    s_nop 0
    s_and_b32 s35, s34, 3
    s_cmp_ge_u32 s34, 2
    s_cbranch_scc1 L_kf_kernel_ncp
    s_getpc_b64 s[38:39]
L_kf_kernel_pc:
    s_sub_u32 s38, s38, L_kf_kernel_pc-kf_kernel
    s_subb_u32 s39, s39, 0
    s_lshr_b32 s36, s2, 3
    s_lshl_b32 s36, s36, 1
    s_add_u32 s36, s36, s34
    s_lshl_b32 s36, s36, 10
    v_lshlrev_b32 v2, 4, v0
    v_add_u32 v2, s36, v2
    v_min_u32 v2, L_kf_kernel_codeend-kf_kernel-16, v2
    v_mov_b32 v3, s39
    v_add_co_u32 v2, vcc, s38, v2
    s_nop 1
    v_addc_co_u32 v3, vcc, 0, v3, vcc
    global_load_dwordx4 v[16:19], v[2:3], off
L_kf_kernel_ncp:
    s_cmp_ge_u32 s34, 4
    s_waitcnt lgkmcnt(0)
    s_mul_i32 s36, s32, 163840
    s_mul_i32 s37, s33, 51200
    s_load_dword s3, s[4:5], s36
    s_load_dword s3, s[10:11], s37
    s_load_dword s3, s[12:13], s37
    s_load_dword s3, s[20:21], 0
    s_load_dword s3, s[20:21], 0xffffc
    s_cmp_ge_u32 s34, 4
    s_cbranch_scc1 L_kf_kernel_M
    s_mul_i32 s36, s32, 163840
    s_add_u32 s40, s4, s36
    s_addc_u32 s41, s5, 0
    s_and_b32 s41, s41, 0xffff
    s_mov_b32 s42, 163840
    s_mov_b32 s43, 0x00020000
    v_lshrrev_b32 v4, 3, v0
    v_and_b32 v5, 7, v0
    v_and_b32 v6, 2, v4
    v_lshrrev_b32 v7, 2, v4
    v_or_b32 v6, v6, v7
    v_xor_b32 v6, v6, v5
    s_mul_i32 s36, s35, 40960
    v_mul_u32_u24 v7, 1280, v4
    v_add_u32 v8, s36, v7
    v_xor_b32 v9, 0, v6
    v_lshl_add_u32 v246, v9, 4, v8
    v_xor_b32 v9, 0, v6
    v_lshl_add_u32 v247, v9, 4, v8
    v_add_u32 v247, 10240, v247
    v_xor_b32 v9, 4, v6
    v_lshl_add_u32 v248, v9, 4, v8
    v_add_u32 v248, 20480, v248
    v_xor_b32 v9, 4, v6
    v_lshl_add_u32 v249, v9, 4, v8
    v_add_u32 v249, 30720, v249
    v_xor_b32 v9, v4, v5
    v_lshl_add_u32 v250, v9, 4, v7
    s_lshl_b32 s37, s35, 12
    s_mov_b32 s36, s35
    s_lshl_b32 s27, s36, 10
    s_add_u32 s27, s27, 16384
    s_and_b32 s39, s36, 1
    s_cmp_eq_u32 s39, 0
    s_cselect_b32 s44, s10, s12
    s_cselect_b32 s45, s11, s13
    s_lshr_b32 s36, s36, 1
    s_lshl_b32 s36, s36, 3
    s_mul_i32 s39, s33, 40
    s_add_u32 s36, s36, s39
    s_mul_i32 s36, s36, 1280
    s_add_u32 s44, s44, s36
    s_addc_u32 s45, s45, 0
    s_and_b32 s45, s45, 0xffff
    s_mov_b32 s46, 10240
    s_mov_b32 s47, 0x00020000
    v_lshrrev_b32 v1, 4, v0
    v_and_b32 v2, 15, v0
    s_lshl_b32 s38, s26, 7
    s_add_u32 m0, s37, 0
    s_nop 0
    buffer_load_dwordx4 v246, s[40:43], s38 offen lds
    s_add_u32 m0, s37, 1024
    s_nop 0
    buffer_load_dwordx4 v247, s[40:43], s38 offen lds
    s_add_u32 m0, s37, 2048
    s_nop 0
    buffer_load_dwordx4 v248, s[40:43], s38 offen lds
    s_add_u32 m0, s37, 3072
    s_nop 0
    buffer_load_dwordx4 v249, s[40:43], s38 offen lds
    s_add_u32 m0, s27, 0
    s_nop 0
    buffer_load_dwordx4 v250, s[44:47], s38 offen lds
    s_add_u32 s26, s26, 1
    s_cmp_eq_u32 s26, 10
    s_cselect_b32 s26, 0, s26
    v_lshrrev_b32 v104, 2, v2
    v_and_b32 v105, 3, v2
    v_lshlrev_b32 v106, 3, v104
    v_add_u32 v106, v106, v105
    s_lshl_b32 s36, s35, 5
    v_add_u32 v106, s36, v106
    v_lshlrev_b32 v106, 7, v106
    v_lshrrev_b32 v107, 1, v104
    v_lshlrev_b32 v107, 2, v107
    v_and_b32 v108, 2, v105
    v_or_b32 v107, v107, v108
    v_xor_b32 v107, v107, v1
    v_xor_b32 v108, 0, v107
    v_lshl_add_u32 v4, v108, 4, v106
    v_xor_b32 v108, 4, v107
    v_lshl_add_u32 v5, v108, 4, v106
    v_xor_b32 v108, 1, v107
    v_lshl_add_u32 v6, v108, 4, v106
    v_add_u32 v6, 512, v6
    v_xor_b32 v108, 5, v107
    v_lshl_add_u32 v7, v108, 4, v106
    v_add_u32 v7, 512, v7
    v_and_b32 v104, 7, v2
    v_xor_b32 v104, v104, v1
    v_lshlrev_b32 v105, 7, v2
    v_xor_b32 v106, 0, v104
    v_lshl_add_u32 v8, v106, 4, v105
    v_add_u32 v8, 16384, v8
    v_xor_b32 v106, 4, v104
    v_lshl_add_u32 v9, v106, 4, v105
    v_add_u32 v9, 16384, v9
    v_mov_b32 v222, 0x3f803f80
    v_mov_b32 v223, 0x3f803f80
    v_mov_b32 v224, 0x3f803f80
    v_mov_b32 v225, 0x3f803f80
    v_mul_u32_u24 v10, 80, v1
    v_lshrrev_b32 v3, 3, v2
    v_cvt_f32_u32 v3, v3
    v_fma_f32 v3, v3, 2.0, -1.0
    s_mov_b32 s20, 1069066811
    s_mov_b32 s21, 1042479491
    s_mul_i32 s36, s33, 22528
    s_add_u32 s36, s36, 15155200
    s_add_u32 s48, s30, s36
    s_addc_u32 s49, s31, 0
    s_and_b32 s49, s49, 0xffff
    s_mov_b32 s50, 22528
    s_mov_b32 s51, 0x00020000
    s_lshl_b32 s38, s26, 7
    s_add_u32 m0, s37, 38912
    s_nop 0
    buffer_load_dwordx4 v246, s[40:43], s38 offen lds
    s_add_u32 m0, s37, 39936
    s_nop 0
    buffer_load_dwordx4 v247, s[40:43], s38 offen lds
    s_add_u32 m0, s37, 40960
    s_nop 0
    buffer_load_dwordx4 v248, s[40:43], s38 offen lds
    s_add_u32 m0, s37, 41984
    s_nop 0
    buffer_load_dwordx4 v249, s[40:43], s38 offen lds
    s_add_u32 m0, s27, 38912
    s_nop 0
    buffer_load_dwordx4 v250, s[44:47], s38 offen lds
    s_add_u32 s26, s26, 1
    s_cmp_eq_u32 s26, 10
    s_cselect_b32 s26, 0, s26
    s_waitcnt vmcnt(5)
    s_barrier
    ds_read_b128 v[56:59], v4
    ds_read_b128 v[60:63], v6
    ds_read_b128 v[72:75], v8 offset:0
    ds_read_b128 v[76:79], v8 offset:2048
    ds_read_b128 v[80:83], v8 offset:4096
    ds_read_b128 v[84:87], v8 offset:6144
    ds_read_b128 v[88:91], v8 offset:8192
    ds_read_b128 v[64:67], v5
    ds_read_b128 v[68:71], v7
    ds_read_b128 v[92:95], v9 offset:0
    ds_read_b128 v[96:99], v9 offset:2048
    ds_read_b128 v[100:103], v9 offset:4096
    ds_read_b128 v[104:107], v9 offset:6144
    ds_read_b128 v[108:111], v9 offset:8192
    v_add_u32 v4, 38912, v4
    v_add_u32 v5, 38912, v5
    v_add_u32 v6, 38912, v6
    v_add_u32 v7, 38912, v7
    v_add_u32 v8, 38912, v8
    v_add_u32 v9, 38912, v9
    s_lshl_b32 s38, s26, 7
    s_add_u32 m0, s37, 77824
    s_nop 0
    buffer_load_dwordx4 v246, s[40:43], s38 offen lds
    s_add_u32 m0, s37, 78848
    s_nop 0
    buffer_load_dwordx4 v247, s[40:43], s38 offen lds
    s_add_u32 m0, s37, 79872
    s_nop 0
    buffer_load_dwordx4 v248, s[40:43], s38 offen lds
    s_add_u32 m0, s37, 80896
    s_nop 0
    buffer_load_dwordx4 v249, s[40:43], s38 offen lds
    s_add_u32 m0, s27, 77824
    s_nop 0
    buffer_load_dwordx4 v250, s[44:47], s38 offen lds
    s_add_u32 s26, s26, 1
    s_cmp_eq_u32 s26, 10
    s_cselect_b32 s26, 0, s26
    s_waitcnt lgkmcnt(0)
    s_waitcnt vmcnt(5)
    s_barrier
    v_mfma_f32_16x16x32_bf16 v[206:209], v[56:59], v[222:225], 0
    ds_read_b128 v[112:115], v4
    v_mfma_f32_16x16x32_bf16 v[214:217], v[56:59], v[56:59], 0
    s_lshl_b32 s38, s26, 7
    s_add_u32 m0, s37, 116736
    s_nop 0
    buffer_load_dwordx4 v246, s[40:43], s38 offen lds
    v_mfma_f32_16x16x32_bf16 v[210:213], v[60:63], v[222:225], 0
    ds_read_b128 v[116:119], v6
    v_mfma_f32_16x16x32_bf16 v[218:221], v[60:63], v[60:63], 0
    s_add_u32 m0, s37, 117760
    s_nop 0
    buffer_load_dwordx4 v247, s[40:43], s38 offen lds
    v_mfma_f32_16x16x32_bf16 v[206:209], v[64:67], v[222:225], v[206:209]
    ds_read_b128 v[128:131], v8 offset:0
    v_mfma_f32_16x16x32_bf16 v[214:217], v[64:67], v[64:67], v[214:217]
    ds_read_b128 v[132:135], v8 offset:2048
    v_mfma_f32_16x16x32_bf16 v[210:213], v[68:71], v[222:225], v[210:213]
    s_add_u32 m0, s37, 118784
    s_nop 0
    buffer_load_dwordx4 v248, s[40:43], s38 offen lds
    v_mfma_f32_16x16x32_bf16 v[218:221], v[68:71], v[68:71], v[218:221]
    ds_read_b128 v[136:139], v8 offset:4096
    v_mfma_f32_16x16x32_bf16 v[16:19], v[56:59], v[72:75], 0
    s_add_u32 m0, s37, 119808
    s_nop 0
    buffer_load_dwordx4 v249, s[40:43], s38 offen lds
    v_mfma_f32_16x16x32_bf16 v[20:23], v[60:63], v[72:75], 0
    ds_read_b128 v[140:143], v8 offset:6144
    v_mfma_f32_16x16x32_bf16 v[24:27], v[56:59], v[76:79], 0
    ds_read_b128 v[144:147], v8 offset:8192
    v_mfma_f32_16x16x32_bf16 v[28:31], v[60:63], v[76:79], 0
    s_add_u32 m0, s27, 116736
    s_nop 0
    buffer_load_dwordx4 v250, s[44:47], s38 offen lds
    s_add_u32 s26, s26, 1
    s_cmp_eq_u32 s26, 10
    s_cselect_b32 s26, 0, s26
    v_mfma_f32_16x16x32_bf16 v[32:35], v[56:59], v[80:83], 0
    ds_read_b128 v[120:123], v5
    v_mfma_f32_16x16x32_bf16 v[36:39], v[60:63], v[80:83], 0
    s_lshl_b32 s38, s26, 7
    s_add_u32 m0, s37, 0
    s_nop 0
    buffer_load_dwordx4 v246, s[40:43], s38 offen lds
    v_mfma_f32_16x16x32_bf16 v[40:43], v[56:59], v[84:87], 0
    ds_read_b128 v[124:127], v7
    v_mfma_f32_16x16x32_bf16 v[44:47], v[60:63], v[84:87], 0
    ds_read_b128 v[148:151], v9 offset:0
    v_mfma_f32_16x16x32_bf16 v[48:51], v[56:59], v[88:91], 0
    s_add_u32 m0, s37, 1024
    s_nop 0
    buffer_load_dwordx4 v247, s[40:43], s38 offen lds
    v_mfma_f32_16x16x32_bf16 v[52:55], v[60:63], v[88:91], 0
    ds_read_b128 v[152:155], v9 offset:2048
    v_mfma_f32_16x16x32_bf16 v[16:19], v[64:67], v[92:95], v[16:19]
    s_add_u32 m0, s37, 2048
    s_nop 0
    buffer_load_dwordx4 v248, s[40:43], s38 offen lds
    v_mfma_f32_16x16x32_bf16 v[20:23], v[68:71], v[92:95], v[20:23]
    ds_read_b128 v[156:159], v9 offset:4096
    v_mfma_f32_16x16x32_bf16 v[24:27], v[64:67], v[96:99], v[24:27]
    ds_read_b128 v[160:163], v9 offset:6144
    v_mfma_f32_16x16x32_bf16 v[28:31], v[68:71], v[96:99], v[28:31]
    s_add_u32 m0, s37, 3072
    s_nop 0
    buffer_load_dwordx4 v249, s[40:43], s38 offen lds
    v_mfma_f32_16x16x32_bf16 v[32:35], v[64:67], v[100:103], v[32:35]
    ds_read_b128 v[164:167], v9 offset:8192
    v_mfma_f32_16x16x32_bf16 v[36:39], v[68:71], v[100:103], v[36:39]
    s_add_u32 m0, s27, 0
    s_nop 0
    buffer_load_dwordx4 v250, s[44:47], s38 offen lds
    s_add_u32 s26, s26, 1
    s_cmp_eq_u32 s26, 10
    s_cselect_b32 s26, 0, s26
    v_mfma_f32_16x16x32_bf16 v[40:43], v[64:67], v[104:107], v[40:43]
    v_add_u32 v4, 38912, v4
    v_add_u32 v5, 38912, v5
    v_add_u32 v6, 38912, v6
    v_add_u32 v7, 38912, v7
    v_add_u32 v8, 38912, v8
    v_add_u32 v9, 38912, v9
    v_mfma_f32_16x16x32_bf16 v[44:47], v[68:71], v[104:107], v[44:47]
    v_mfma_f32_16x16x32_bf16 v[48:51], v[64:67], v[108:111], v[48:51]
    v_mfma_f32_16x16x32_bf16 v[52:55], v[68:71], v[108:111], v[52:55]
    s_waitcnt lgkmcnt(0)
    s_waitcnt vmcnt(10)
    s_barrier
    v_and_b32 v11, 7, v0
    v_lshlrev_b32 v11, 1, v11
    v_add_u32 v11, 155648, v11
    v_lshlrev_b32 v12, 4, v1
    v_add_u32 v12, v11, v12
    ds_read_u16 v178, v11 offset:0
    ds_read_u16 v183, v11 offset:128
    ds_read_u16 v188, v11 offset:256
    ds_read_u16 v179, v11 offset:16
    ds_read_u16 v184, v11 offset:144
    ds_read_u16 v189, v11 offset:272
    ds_read_u16 v180, v11 offset:32
    ds_read_u16 v185, v11 offset:160
    ds_read_u16 v190, v11 offset:288
    ds_read_u16 v181, v11 offset:48
    ds_read_u16 v186, v11 offset:176
    ds_read_u16 v191, v11 offset:304
    ds_read_u16 v182, v11 offset:64
    ds_read_u16 v187, v11 offset:192
    ds_read_u16 v192, v11 offset:320
    ds_read_u16 v202, v12 offset:0
    ds_read_u16 v204, v12 offset:128
    ds_read_u16 v203, v12 offset:256
    v_mfma_f32_16x16x32_bf16 v[206:209], v[112:115], v[222:225], v[206:209]
    ds_read_b128 v[56:59], v4
    v_mfma_f32_16x16x32_bf16 v[214:217], v[112:115], v[112:115], v[214:217]
    s_lshl_b32 s38, s26, 7
    s_add_u32 m0, s37, 38912
    s_nop 0
    buffer_load_dwordx4 v246, s[40:43], s38 offen lds
    v_mfma_f32_16x16x32_bf16 v[210:213], v[116:119], v[222:225], v[210:213]
    ds_read_b128 v[60:63], v6
    v_mfma_f32_16x16x32_bf16 v[218:221], v[116:119], v[116:119], v[218:221]
    ds_read_b128 v[72:75], v8 offset:0
    v_mfma_f32_16x16x32_bf16 v[206:209], v[120:123], v[222:225], v[206:209]
    v_mfma_f32_16x16x32_bf16 v[214:217], v[120:123], v[120:123], v[214:217]
    ds_read_b128 v[76:79], v8 offset:2048
    v_mfma_f32_16x16x32_bf16 v[210:213], v[124:127], v[222:225], v[210:213]
    s_add_u32 m0, s37, 39936
    s_nop 0
    buffer_load_dwordx4 v247, s[40:43], s38 offen lds
    v_mfma_f32_16x16x32_bf16 v[218:221], v[124:127], v[124:127], v[218:221]
    ds_read_b128 v[80:83], v8 offset:4096
    v_mfma_f32_16x16x32_bf16 v[16:19], v[112:115], v[128:131], v[16:19]
    ds_read_b128 v[84:87], v8 offset:6144
    v_mfma_f32_16x16x32_bf16 v[20:23], v[116:119], v[128:131], v[20:23]
    v_mfma_f32_16x16x32_bf16 v[24:27], v[112:115], v[132:135], v[24:27]
    ds_read_b128 v[88:91], v8 offset:8192
    v_mfma_f32_16x16x32_bf16 v[28:31], v[116:119], v[132:135], v[28:31]
    s_add_u32 m0, s37, 40960
    s_nop 0
    buffer_load_dwordx4 v248, s[40:43], s38 offen lds
    v_mfma_f32_16x16x32_bf16 v[32:35], v[112:115], v[136:139], v[32:35]
    ds_read_b128 v[64:67], v5
    v_mfma_f32_16x16x32_bf16 v[36:39], v[116:119], v[136:139], v[36:39]
    ds_read_b128 v[68:71], v7
    v_mfma_f32_16x16x32_bf16 v[40:43], v[112:115], v[140:143], v[40:43]
    v_mfma_f32_16x16x32_bf16 v[44:47], v[116:119], v[140:143], v[44:47]
    ds_read_b128 v[92:95], v9 offset:0
    v_mfma_f32_16x16x32_bf16 v[48:51], v[112:115], v[144:147], v[48:51]
    s_add_u32 m0, s37, 41984
    s_nop 0
    buffer_load_dwordx4 v249, s[40:43], s38 offen lds
    v_mfma_f32_16x16x32_bf16 v[52:55], v[116:119], v[144:147], v[52:55]
    ds_read_b128 v[96:99], v9 offset:2048
    v_mfma_f32_16x16x32_bf16 v[16:19], v[120:123], v[148:151], v[16:19]
    ds_read_b128 v[100:103], v9 offset:4096
    v_mfma_f32_16x16x32_bf16 v[20:23], v[124:127], v[148:151], v[20:23]
    v_mfma_f32_16x16x32_bf16 v[24:27], v[120:123], v[152:155], v[24:27]
    ds_read_b128 v[104:107], v9 offset:6144
    v_mfma_f32_16x16x32_bf16 v[28:31], v[124:127], v[152:155], v[28:31]
    s_add_u32 m0, s27, 38912
    s_nop 0
    buffer_load_dwordx4 v250, s[44:47], s38 offen lds
    s_add_u32 s26, s26, 1
    s_cmp_eq_u32 s26, 10
    s_cselect_b32 s26, 0, s26
    v_mfma_f32_16x16x32_bf16 v[32:35], v[120:123], v[156:159], v[32:35]
    ds_read_b128 v[108:111], v9 offset:8192
    v_mfma_f32_16x16x32_bf16 v[36:39], v[124:127], v[156:159], v[36:39]
    v_add_u32 v4, 38912, v4
    v_add_u32 v5, 38912, v5
    v_add_u32 v6, 38912, v6
    v_add_u32 v7, 38912, v7
    v_add_u32 v8, 38912, v8
    v_add_u32 v9, 38912, v9
    v_mfma_f32_16x16x32_bf16 v[40:43], v[120:123], v[160:163], v[40:43]
    v_mfma_f32_16x16x32_bf16 v[44:47], v[124:127], v[160:163], v[44:47]
    v_mfma_f32_16x16x32_bf16 v[48:51], v[120:123], v[164:167], v[48:51]
    v_mfma_f32_16x16x32_bf16 v[52:55], v[124:127], v[164:167], v[52:55]
    s_waitcnt lgkmcnt(0)
    s_waitcnt vmcnt(10)
    s_barrier
    v_mfma_f32_16x16x32_bf16 v[206:209], v[56:59], v[222:225], v[206:209]
    ds_read_b128 v[112:115], v4
    s_lshl_b32 s36, s35, 2
    v_add_u32 v245, s36, v1
    v_mfma_f32_16x16x32_bf16 v[214:217], v[56:59], v[56:59], v[214:217]
    v_lshlrev_b32 v245, 3, v245
    s_lshl_b32 s38, s26, 7
    s_add_u32 m0, s37, 77824
    s_nop 0
    buffer_load_dwordx4 v246, s[40:43], s38 offen lds
    v_mfma_f32_16x16x32_bf16 v[210:213], v[60:63], v[222:225], v[210:213]
    v_cvt_f32_u32 v245, v245
    v_lshlrev_b32 v178, 16, v178
    ds_read_b128 v[116:119], v6
    v_mfma_f32_16x16x32_bf16 v[218:221], v[60:63], v[60:63], v[218:221]
    v_lshlrev_b32 v183, 16, v183
    v_lshlrev_b32 v11, 16, v188
    v_mfma_f32_16x16x32_bf16 v[206:209], v[64:67], v[222:225], v[206:209]
    ds_read_b128 v[128:131], v8 offset:0
    v_mul_f32 v11, s20, v11
    v_exp_f32 v11, v11
    v_mfma_f32_16x16x32_bf16 v[214:217], v[64:67], v[64:67], v[214:217]
    ds_read_b128 v[132:135], v8 offset:2048
    v_cvt_pk_bf16_f32 v11, 0, v11
    v_mfma_f32_16x16x32_bf16 v[210:213], v[68:71], v[222:225], v[210:213]
    v_mul_f32 v12, v11, v178
    s_add_u32 m0, s37, 78848
    s_nop 0
    buffer_load_dwordx4 v247, s[40:43], s38 offen lds
    v_mul_f32 v13, v11, v183
    v_mfma_f32_16x16x32_bf16 v[218:221], v[68:71], v[68:71], v[218:221]
    v_mul_f32 v242, s20, v12
    ds_read_b128 v[136:139], v8 offset:4096
    v_mfma_f32_16x16x32_bf16 v[16:19], v[56:59], v[72:75], v[16:19]
    v_mul_f32 v243, s21, v13
    v_exp_f32 v11, v242
    v_mfma_f32_16x16x32_bf16 v[20:23], v[60:63], v[72:75], v[20:23]
    ds_read_b128 v[140:143], v8 offset:6144
    v_fract_f32 v12, v243
    v_cos_f32 v13, v12
    v_mfma_f32_16x16x32_bf16 v[24:27], v[56:59], v[76:79], v[24:27]
    ds_read_b128 v[144:147], v8 offset:8192
    v_sin_f32 v14, v12
    v_mfma_f32_16x16x32_bf16 v[28:31], v[60:63], v[76:79], v[28:31]
    v_mul_f32 v14, v11, v14
    s_add_u32 m0, s37, 79872
    s_nop 0
    buffer_load_dwordx4 v248, s[40:43], s38 offen lds
    v_mul_f32 v168, v11, v13
    v_mfma_f32_16x16x32_bf16 v[32:35], v[56:59], v[80:83], v[32:35]
    v_mul_f32 v173, v14, v3
    ds_read_b128 v[120:123], v5
    v_mfma_f32_16x16x32_bf16 v[36:39], v[60:63], v[80:83], v[36:39]
    v_add_f32 v11, -1.0, v168
    v_mul_f32 v12, v178, v178
    ds_read_b128 v[124:127], v7
    v_mfma_f32_16x16x32_bf16 v[40:43], v[56:59], v[84:87], v[40:43]
    v_fmac_f32 v12, v183, v183
    v_rcp_f32 v12, v12
    v_mfma_f32_16x16x32_bf16 v[44:47], v[60:63], v[84:87], v[44:47]
    ds_read_b128 v[148:151], v9 offset:0
    v_mul_f32 v13, v11, v178
    v_fmac_f32 v13, v14, v183
    v_mfma_f32_16x16x32_bf16 v[48:51], v[56:59], v[88:91], v[48:51]
    s_add_u32 m0, s37, 80896
    s_nop 0
    buffer_load_dwordx4 v249, s[40:43], s38 offen lds
    v_mul_f32 v244, v14, v178
    v_mfma_f32_16x16x32_bf16 v[52:55], v[60:63], v[88:91], v[52:55]
    v_fma_f32 v244, -v11, v183, v244
    ds_read_b128 v[152:155], v9 offset:2048
    v_mfma_f32_16x16x32_bf16 v[16:19], v[64:67], v[92:95], v[16:19]
    v_mul_f32 v12, -2.0, v12
    v_mul_f32 v183, v244, v12
    ds_read_b128 v[156:159], v9 offset:4096
    v_mfma_f32_16x16x32_bf16 v[20:23], v[68:71], v[92:95], v[20:23]
    v_mul_f32 v13, v13, v12
    v_mul_f32 v178, v13, v3
    v_mfma_f32_16x16x32_bf16 v[24:27], v[64:67], v[96:99], v[24:27]
    ds_read_b128 v[160:163], v9 offset:6144
    v_mul_f32 v11, v245, v242
    v_mul_f32 v12, v245, v243
    v_mfma_f32_16x16x32_bf16 v[28:31], v[68:71], v[96:99], v[28:31]
    s_add_u32 m0, s27, 77824
    s_nop 0
    buffer_load_dwordx4 v250, s[44:47], s38 offen lds
    s_add_u32 s26, s26, 1
    s_cmp_eq_u32 s26, 10
    s_cselect_b32 s26, 0, s26
    v_exp_f32 v11, v11
    v_mfma_f32_16x16x32_bf16 v[32:35], v[64:67], v[100:103], v[32:35]
    v_fract_f32 v12, v12
    ds_read_b128 v[164:167], v9 offset:8192
    v_cos_f32 v13, v12
    v_mfma_f32_16x16x32_bf16 v[36:39], v[68:71], v[100:103], v[36:39]
    v_sin_f32 v14, v12
    v_add_u32 v4, 4294850560, v4
    v_add_u32 v5, 4294850560, v5
    v_add_u32 v6, 4294850560, v6
    v_add_u32 v7, 4294850560, v7
    v_add_u32 v8, 4294850560, v8
    v_add_u32 v9, 4294850560, v9
    v_mfma_f32_16x16x32_bf16 v[40:43], v[64:67], v[104:107], v[40:43]
    v_mul_f32 v14, v11, v14
    v_mul_f32 v188, v11, v13
    v_mfma_f32_16x16x32_bf16 v[44:47], v[68:71], v[104:107], v[44:47]
    v_mfma_f32_16x16x32_bf16 v[48:51], v[64:67], v[108:111], v[48:51]
    v_mfma_f32_16x16x32_bf16 v[52:55], v[68:71], v[108:111], v[52:55]
    s_waitcnt lgkmcnt(0)
    s_waitcnt vmcnt(10)
    s_barrier
    v_mfma_f32_16x16x32_bf16 v[206:209], v[112:115], v[222:225], v[206:209]
    ds_read_b128 v[56:59], v4
    v_mul_f32 v193, v14, v3
    v_lshlrev_b32 v179, 16, v179
    v_mfma_f32_16x16x32_bf16 v[214:217], v[112:115], v[112:115], v[214:217]
    v_lshlrev_b32 v184, 16, v184
    s_lshl_b32 s38, s26, 7
    s_add_u32 m0, s37, 116736
    s_nop 0
    buffer_load_dwordx4 v246, s[40:43], s38 offen lds
    v_mfma_f32_16x16x32_bf16 v[210:213], v[116:119], v[222:225], v[210:213]
    v_lshlrev_b32 v11, 16, v189
    v_mul_f32 v11, s20, v11
    ds_read_b128 v[60:63], v6
    v_mfma_f32_16x16x32_bf16 v[218:221], v[116:119], v[116:119], v[218:221]
    v_exp_f32 v11, v11
    s_nop 0
    v_cvt_pk_bf16_f32 v11, 0, v11
    v_mfma_f32_16x16x32_bf16 v[206:209], v[120:123], v[222:225], v[206:209]
    ds_read_b128 v[72:75], v8 offset:0
    v_mul_f32 v12, v11, v179
    v_mul_f32 v13, v11, v184
    v_mfma_f32_16x16x32_bf16 v[214:217], v[120:123], v[120:123], v[214:217]
    ds_read_b128 v[76:79], v8 offset:2048
    v_mul_f32 v242, s20, v12
    v_mfma_f32_16x16x32_bf16 v[210:213], v[124:127], v[222:225], v[210:213]
    v_mul_f32 v243, s21, v13
    s_add_u32 m0, s37, 117760
    s_nop 0
    buffer_load_dwordx4 v247, s[40:43], s38 offen lds
    v_exp_f32 v11, v242
    v_mfma_f32_16x16x32_bf16 v[218:221], v[124:127], v[124:127], v[218:221]
    v_fract_f32 v12, v243
    ds_read_b128 v[80:83], v8 offset:4096
    v_mfma_f32_16x16x32_bf16 v[16:19], v[112:115], v[128:131], v[16:19]
    v_cos_f32 v13, v12
    v_sin_f32 v14, v12
    v_mfma_f32_16x16x32_bf16 v[20:23], v[116:119], v[128:131], v[20:23]
    ds_read_b128 v[84:87], v8 offset:6144
    v_mul_f32 v14, v11, v14
    v_mul_f32 v169, v11, v13
    v_mfma_f32_16x16x32_bf16 v[24:27], v[112:115], v[132:135], v[24:27]
    ds_read_b128 v[88:91], v8 offset:8192
    v_mul_f32 v174, v14, v3
    v_mfma_f32_16x16x32_bf16 v[28:31], v[116:119], v[132:135], v[28:31]
    v_add_f32 v11, -1.0, v169
    s_add_u32 m0, s37, 118784
    s_nop 0
    buffer_load_dwordx4 v248, s[40:43], s38 offen lds
    v_mul_f32 v12, v179, v179
    v_mfma_f32_16x16x32_bf16 v[32:35], v[112:115], v[136:139], v[32:35]
    v_fmac_f32 v12, v184, v184
    ds_read_b128 v[64:67], v5
    v_mfma_f32_16x16x32_bf16 v[36:39], v[116:119], v[136:139], v[36:39]
    v_rcp_f32 v12, v12
    v_mul_f32 v13, v11, v179
    ds_read_b128 v[68:71], v7
    v_mfma_f32_16x16x32_bf16 v[40:43], v[112:115], v[140:143], v[40:43]
    v_fmac_f32 v13, v14, v184
    v_mul_f32 v244, v14, v179
    v_mfma_f32_16x16x32_bf16 v[44:47], v[116:119], v[140:143], v[44:47]
    ds_read_b128 v[92:95], v9 offset:0
    v_fma_f32 v244, -v11, v184, v244
    v_mul_f32 v12, -2.0, v12
    v_mfma_f32_16x16x32_bf16 v[48:51], v[112:115], v[144:147], v[48:51]
    s_add_u32 m0, s37, 119808
    s_nop 0
    buffer_load_dwordx4 v249, s[40:43], s38 offen lds
    v_mul_f32 v184, v244, v12
    v_mfma_f32_16x16x32_bf16 v[52:55], v[116:119], v[144:147], v[52:55]
    v_mul_f32 v13, v13, v12
    ds_read_b128 v[96:99], v9 offset:2048
    v_mfma_f32_16x16x32_bf16 v[16:19], v[120:123], v[148:151], v[16:19]
    v_mul_f32 v179, v13, v3
    v_mul_f32 v11, v245, v242
    ds_read_b128 v[100:103], v9 offset:4096
    v_mfma_f32_16x16x32_bf16 v[20:23], v[124:127], v[148:151], v[20:23]
    v_mul_f32 v12, v245, v243
    v_exp_f32 v11, v11
    v_mfma_f32_16x16x32_bf16 v[24:27], v[120:123], v[152:155], v[24:27]
    ds_read_b128 v[104:107], v9 offset:6144
    v_fract_f32 v12, v12
    v_cos_f32 v13, v12
    v_mfma_f32_16x16x32_bf16 v[28:31], v[124:127], v[152:155], v[28:31]
    s_add_u32 m0, s27, 116736
    s_nop 0
    buffer_load_dwordx4 v250, s[44:47], s38 offen lds
    s_add_u32 s26, s26, 1
    s_cmp_eq_u32 s26, 10
    s_cselect_b32 s26, 0, s26
    v_sin_f32 v14, v12
    v_mfma_f32_16x16x32_bf16 v[32:35], v[120:123], v[156:159], v[32:35]
    v_mul_f32 v14, v11, v14
    ds_read_b128 v[108:111], v9 offset:8192
    v_mul_f32 v189, v11, v13
    v_mfma_f32_16x16x32_bf16 v[36:39], v[124:127], v[156:159], v[36:39]
    v_mul_f32 v194, v14, v3
    v_add_u32 v4, 38912, v4
    v_add_u32 v5, 38912, v5
    v_add_u32 v6, 38912, v6
    v_add_u32 v7, 38912, v7
    v_add_u32 v8, 38912, v8
    v_add_u32 v9, 38912, v9
    v_mfma_f32_16x16x32_bf16 v[40:43], v[120:123], v[160:163], v[40:43]
    v_lshlrev_b32 v180, 16, v180
    v_lshlrev_b32 v185, 16, v185
    v_mfma_f32_16x16x32_bf16 v[44:47], v[124:127], v[160:163], v[44:47]
    v_mfma_f32_16x16x32_bf16 v[48:51], v[120:123], v[164:167], v[48:51]
    v_mfma_f32_16x16x32_bf16 v[52:55], v[124:127], v[164:167], v[52:55]
    s_waitcnt lgkmcnt(0)
    s_waitcnt vmcnt(10)
    s_barrier
    v_mfma_f32_16x16x32_bf16 v[206:209], v[56:59], v[222:225], v[206:209]
    ds_read_b128 v[112:115], v4
    v_lshlrev_b32 v11, 16, v190
    v_mul_f32 v11, s20, v11
    v_mfma_f32_16x16x32_bf16 v[214:217], v[56:59], v[56:59], v[214:217]
    v_exp_f32 v11, v11
    s_lshl_b32 s38, s26, 7
    s_add_u32 m0, s37, 0
    s_nop 0
    buffer_load_dwordx4 v246, s[40:43], s38 offen lds
    v_mfma_f32_16x16x32_bf16 v[210:213], v[60:63], v[222:225], v[210:213]
    v_cvt_pk_bf16_f32 v11, 0, v11
    v_mul_f32 v12, v11, v180
    ds_read_b128 v[116:119], v6
    v_mfma_f32_16x16x32_bf16 v[218:221], v[60:63], v[60:63], v[218:221]
    v_mul_f32 v13, v11, v185
    v_mul_f32 v242, s20, v12
    v_mfma_f32_16x16x32_bf16 v[206:209], v[64:67], v[222:225], v[206:209]
    ds_read_b128 v[128:131], v8 offset:0
    v_mul_f32 v243, s21, v13
    v_exp_f32 v11, v242
    v_mfma_f32_16x16x32_bf16 v[214:217], v[64:67], v[64:67], v[214:217]
    ds_read_b128 v[132:135], v8 offset:2048
    v_fract_f32 v12, v243
    v_mfma_f32_16x16x32_bf16 v[210:213], v[68:71], v[222:225], v[210:213]
    v_cos_f32 v13, v12
    s_add_u32 m0, s37, 1024
    s_nop 0
    buffer_load_dwordx4 v247, s[40:43], s38 offen lds
    v_sin_f32 v14, v12
    v_mfma_f32_16x16x32_bf16 v[218:221], v[68:71], v[68:71], v[218:221]
    v_mul_f32 v14, v11, v14
    ds_read_b128 v[136:139], v8 offset:4096
    v_mfma_f32_16x16x32_bf16 v[16:19], v[56:59], v[72:75], v[16:19]
    v_mul_f32 v170, v11, v13
    v_mul_f32 v175, v14, v3
    v_mfma_f32_16x16x32_bf16 v[20:23], v[60:63], v[72:75], v[20:23]
    ds_read_b128 v[140:143], v8 offset:6144
    v_add_f32 v11, -1.0, v170
    v_mul_f32 v12, v180, v180
    v_mfma_f32_16x16x32_bf16 v[24:27], v[56:59], v[76:79], v[24:27]
    ds_read_b128 v[144:147], v8 offset:8192
    v_fmac_f32 v12, v185, v185
    v_mfma_f32_16x16x32_bf16 v[28:31], v[60:63], v[76:79], v[28:31]
    v_rcp_f32 v12, v12
    s_add_u32 m0, s37, 2048
    s_nop 0
    buffer_load_dwordx4 v248, s[40:43], s38 offen lds
    v_mul_f32 v13, v11, v180
    v_mfma_f32_16x16x32_bf16 v[32:35], v[56:59], v[80:83], v[32:35]
    v_fmac_f32 v13, v14, v185
    ds_read_b128 v[120:123], v5
    v_mfma_f32_16x16x32_bf16 v[36:39], v[60:63], v[80:83], v[36:39]
    v_mul_f32 v244, v14, v180
    v_fma_f32 v244, -v11, v185, v244
    ds_read_b128 v[124:127], v7
    v_mfma_f32_16x16x32_bf16 v[40:43], v[56:59], v[84:87], v[40:43]
    v_mul_f32 v12, -2.0, v12
    v_mul_f32 v185, v244, v12
    v_mfma_f32_16x16x32_bf16 v[44:47], v[60:63], v[84:87], v[44:47]
    ds_read_b128 v[148:151], v9 offset:0
    v_mul_f32 v13, v13, v12
    v_mul_f32 v180, v13, v3
    v_mfma_f32_16x16x32_bf16 v[48:51], v[56:59], v[88:91], v[48:51]
    s_add_u32 m0, s37, 3072
    s_nop 0
    buffer_load_dwordx4 v249, s[40:43], s38 offen lds
    v_mul_f32 v11, v245, v242
    v_mfma_f32_16x16x32_bf16 v[52:55], v[60:63], v[88:91], v[52:55]
    v_mul_f32 v12, v245, v243
    ds_read_b128 v[152:155], v9 offset:2048
    v_mfma_f32_16x16x32_bf16 v[16:19], v[64:67], v[92:95], v[16:19]
    v_exp_f32 v11, v11
    v_fract_f32 v12, v12
    ds_read_b128 v[156:159], v9 offset:4096
    v_mfma_f32_16x16x32_bf16 v[20:23], v[68:71], v[92:95], v[20:23]
    v_cos_f32 v13, v12
    v_sin_f32 v14, v12
    v_mfma_f32_16x16x32_bf16 v[24:27], v[64:67], v[96:99], v[24:27]
    ds_read_b128 v[160:163], v9 offset:6144
    v_mul_f32 v14, v11, v14
    v_mul_f32 v190, v11, v13
    v_mfma_f32_16x16x32_bf16 v[28:31], v[68:71], v[96:99], v[28:31]
    s_add_u32 m0, s27, 0
    s_nop 0
    buffer_load_dwordx4 v250, s[44:47], s38 offen lds
    s_add_u32 s26, s26, 1
    s_cmp_eq_u32 s26, 10
    s_cselect_b32 s26, 0, s26
    v_mul_f32 v195, v14, v3
    v_mfma_f32_16x16x32_bf16 v[32:35], v[64:67], v[100:103], v[32:35]
    v_lshlrev_b32 v181, 16, v181
    ds_read_b128 v[164:167], v9 offset:8192
    v_lshlrev_b32 v186, 16, v186
    v_mfma_f32_16x16x32_bf16 v[36:39], v[68:71], v[100:103], v[36:39]
    v_lshlrev_b32 v11, 16, v191
    v_add_u32 v4, 38912, v4
    v_add_u32 v5, 38912, v5
    v_add_u32 v6, 38912, v6
    v_add_u32 v7, 38912, v7
    v_add_u32 v8, 38912, v8
    v_add_u32 v9, 38912, v9
    v_mfma_f32_16x16x32_bf16 v[40:43], v[64:67], v[104:107], v[40:43]
    v_mul_f32 v11, s20, v11
    v_exp_f32 v11, v11
    v_mfma_f32_16x16x32_bf16 v[44:47], v[68:71], v[104:107], v[44:47]
    v_mfma_f32_16x16x32_bf16 v[48:51], v[64:67], v[108:111], v[48:51]
    v_mfma_f32_16x16x32_bf16 v[52:55], v[68:71], v[108:111], v[52:55]
    s_waitcnt lgkmcnt(0)
    s_waitcnt vmcnt(10)
    s_barrier
    v_mfma_f32_16x16x32_bf16 v[206:209], v[112:115], v[222:225], v[206:209]
    ds_read_b128 v[56:59], v4
    v_cvt_pk_bf16_f32 v11, 0, v11
    v_mul_f32 v12, v11, v181
    v_mfma_f32_16x16x32_bf16 v[214:217], v[112:115], v[112:115], v[214:217]
    v_mul_f32 v13, v11, v186
    s_lshl_b32 s38, s26, 7
    s_add_u32 m0, s37, 38912
    s_nop 0
    buffer_load_dwordx4 v246, s[40:43], s38 offen lds
    v_mfma_f32_16x16x32_bf16 v[210:213], v[116:119], v[222:225], v[210:213]
    v_mul_f32 v242, s20, v12
    v_mul_f32 v243, s21, v13
    ds_read_b128 v[60:63], v6
    v_mfma_f32_16x16x32_bf16 v[218:221], v[116:119], v[116:119], v[218:221]
    v_exp_f32 v11, v242
    v_fract_f32 v12, v243
    v_mfma_f32_16x16x32_bf16 v[206:209], v[120:123], v[222:225], v[206:209]
    ds_read_b128 v[72:75], v8 offset:0
    v_cos_f32 v13, v12
    v_sin_f32 v14, v12
    v_mfma_f32_16x16x32_bf16 v[214:217], v[120:123], v[120:123], v[214:217]
    ds_read_b128 v[76:79], v8 offset:2048
    v_mul_f32 v14, v11, v14
    v_mfma_f32_16x16x32_bf16 v[210:213], v[124:127], v[222:225], v[210:213]
    v_mul_f32 v171, v11, v13
    s_add_u32 m0, s37, 39936
    s_nop 0
    buffer_load_dwordx4 v247, s[40:43], s38 offen lds
    v_mul_f32 v176, v14, v3
    v_mfma_f32_16x16x32_bf16 v[218:221], v[124:127], v[124:127], v[218:221]
    v_add_f32 v11, -1.0, v171
    ds_read_b128 v[80:83], v8 offset:4096
    v_mfma_f32_16x16x32_bf16 v[16:19], v[112:115], v[128:131], v[16:19]
    v_mul_f32 v12, v181, v181
    v_fmac_f32 v12, v186, v186
    v_mfma_f32_16x16x32_bf16 v[20:23], v[116:119], v[128:131], v[20:23]
    ds_read_b128 v[84:87], v8 offset:6144
    v_rcp_f32 v12, v12
    v_mul_f32 v13, v11, v181
    v_mfma_f32_16x16x32_bf16 v[24:27], v[112:115], v[132:135], v[24:27]
    ds_read_b128 v[88:91], v8 offset:8192
    v_fmac_f32 v13, v14, v186
    v_mfma_f32_16x16x32_bf16 v[28:31], v[116:119], v[132:135], v[28:31]
    v_mul_f32 v244, v14, v181
    s_add_u32 m0, s37, 40960
    s_nop 0
    buffer_load_dwordx4 v248, s[40:43], s38 offen lds
    v_fma_f32 v244, -v11, v186, v244
    v_mfma_f32_16x16x32_bf16 v[32:35], v[112:115], v[136:139], v[32:35]
    v_mul_f32 v12, -2.0, v12
    ds_read_b128 v[64:67], v5
    v_mfma_f32_16x16x32_bf16 v[36:39], v[116:119], v[136:139], v[36:39]
    v_mul_f32 v186, v244, v12
    v_mul_f32 v13, v13, v12
    ds_read_b128 v[68:71], v7
    v_mfma_f32_16x16x32_bf16 v[40:43], v[112:115], v[140:143], v[40:43]
    v_mul_f32 v181, v13, v3
    v_mul_f32 v11, v245, v242
    v_mfma_f32_16x16x32_bf16 v[44:47], v[116:119], v[140:143], v[44:47]
    ds_read_b128 v[92:95], v9 offset:0
    v_mul_f32 v12, v245, v243
    v_exp_f32 v11, v11
    v_mfma_f32_16x16x32_bf16 v[48:51], v[112:115], v[144:147], v[48:51]
    s_add_u32 m0, s37, 41984
    s_nop 0
    buffer_load_dwordx4 v249, s[40:43], s38 offen lds
    v_fract_f32 v12, v12
    v_mfma_f32_16x16x32_bf16 v[52:55], v[116:119], v[144:147], v[52:55]
    v_cos_f32 v13, v12
    ds_read_b128 v[96:99], v9 offset:2048
    v_mfma_f32_16x16x32_bf16 v[16:19], v[120:123], v[148:151], v[16:19]
    v_sin_f32 v14, v12
    s_nop 0
    v_mul_f32 v14, v11, v14
    ds_read_b128 v[100:103], v9 offset:4096
    v_mfma_f32_16x16x32_bf16 v[20:23], v[124:127], v[148:151], v[20:23]
    v_mul_f32 v191, v11, v13
    v_mul_f32 v196, v14, v3
    v_mfma_f32_16x16x32_bf16 v[24:27], v[120:123], v[152:155], v[24:27]
    ds_read_b128 v[104:107], v9 offset:6144
    v_lshlrev_b32 v182, 16, v182
    v_lshlrev_b32 v187, 16, v187
    v_mfma_f32_16x16x32_bf16 v[28:31], v[124:127], v[152:155], v[28:31]
    s_add_u32 m0, s27, 38912
    s_nop 0
    buffer_load_dwordx4 v250, s[44:47], s38 offen lds
    s_add_u32 s26, s26, 1
    s_cmp_eq_u32 s26, 10
    s_cselect_b32 s26, 0, s26
    v_lshlrev_b32 v11, 16, v192
    v_mfma_f32_16x16x32_bf16 v[32:35], v[120:123], v[156:159], v[32:35]
    v_mul_f32 v11, s20, v11
    ds_read_b128 v[108:111], v9 offset:8192
    v_exp_f32 v11, v11
    v_mfma_f32_16x16x32_bf16 v[36:39], v[124:127], v[156:159], v[36:39]
    v_cvt_pk_bf16_f32 v11, 0, v11
    v_add_u32 v4, 38912, v4
    v_add_u32 v5, 38912, v5
    v_add_u32 v6, 38912, v6
    v_add_u32 v7, 38912, v7
    v_add_u32 v8, 38912, v8
    v_add_u32 v9, 38912, v9
    v_mfma_f32_16x16x32_bf16 v[40:43], v[120:123], v[160:163], v[40:43]
    v_mul_f32 v12, v11, v182
    v_mul_f32 v13, v11, v187
    v_mfma_f32_16x16x32_bf16 v[44:47], v[124:127], v[160:163], v[44:47]
    v_mfma_f32_16x16x32_bf16 v[48:51], v[120:123], v[164:167], v[48:51]
    v_mfma_f32_16x16x32_bf16 v[52:55], v[124:127], v[164:167], v[52:55]
    s_waitcnt lgkmcnt(0)
    s_waitcnt vmcnt(10)
    s_barrier
    v_mfma_f32_16x16x32_bf16 v[206:209], v[56:59], v[222:225], v[206:209]
    ds_read_b128 v[112:115], v4
    v_mul_f32 v242, s20, v12
    v_mul_f32 v243, s21, v13
    v_mfma_f32_16x16x32_bf16 v[214:217], v[56:59], v[56:59], v[214:217]
    v_exp_f32 v11, v242
    ds_read_b128 v[116:119], v6
    v_mfma_f32_16x16x32_bf16 v[210:213], v[60:63], v[222:225], v[210:213]
    v_fract_f32 v12, v243
    v_cos_f32 v13, v12
    v_mfma_f32_16x16x32_bf16 v[218:221], v[60:63], v[60:63], v[218:221]
    v_sin_f32 v14, v12
    ds_read_b128 v[128:131], v8 offset:0
    v_mfma_f32_16x16x32_bf16 v[206:209], v[64:67], v[222:225], v[206:209]
    v_mul_f32 v14, v11, v14
    v_mul_f32 v172, v11, v13
    v_mul_f32 v177, v14, v3
    v_mfma_f32_16x16x32_bf16 v[214:217], v[64:67], v[64:67], v[214:217]
    ds_read_b128 v[132:135], v8 offset:2048
    v_add_f32 v11, -1.0, v172
    v_mfma_f32_16x16x32_bf16 v[210:213], v[68:71], v[222:225], v[210:213]
    v_mul_f32 v12, v182, v182
    ds_read_b128 v[136:139], v8 offset:4096
    v_mfma_f32_16x16x32_bf16 v[218:221], v[68:71], v[68:71], v[218:221]
    v_fmac_f32 v12, v187, v187
    v_rcp_f32 v12, v12
    v_mfma_f32_16x16x32_bf16 v[16:19], v[56:59], v[72:75], v[16:19]
    v_mul_f32 v13, v11, v182
    ds_read_b128 v[140:143], v8 offset:6144
    v_fmac_f32 v13, v14, v187
    v_mfma_f32_16x16x32_bf16 v[20:23], v[60:63], v[72:75], v[20:23]
    v_mul_f32 v244, v14, v182
    v_fma_f32 v244, -v11, v187, v244
    v_mfma_f32_16x16x32_bf16 v[24:27], v[56:59], v[76:79], v[24:27]
    ds_read_b128 v[144:147], v8 offset:8192
    v_mul_f32 v12, -2.0, v12
    v_mfma_f32_16x16x32_bf16 v[28:31], v[60:63], v[76:79], v[28:31]
    v_mul_f32 v187, v244, v12
    v_mul_f32 v13, v13, v12
    v_mfma_f32_16x16x32_bf16 v[32:35], v[56:59], v[80:83], v[32:35]
    ds_read_b128 v[120:123], v5
    v_mul_f32 v182, v13, v3
    v_mul_f32 v11, v245, v242
    v_mfma_f32_16x16x32_bf16 v[36:39], v[60:63], v[80:83], v[36:39]
    ds_read_b128 v[124:127], v7
    v_mul_f32 v12, v245, v243
    v_mfma_f32_16x16x32_bf16 v[40:43], v[56:59], v[84:87], v[40:43]
    v_exp_f32 v11, v11
    v_fract_f32 v12, v12
    v_mfma_f32_16x16x32_bf16 v[44:47], v[60:63], v[84:87], v[44:47]
    ds_read_b128 v[148:151], v9 offset:0
    v_cos_f32 v13, v12
    v_mfma_f32_16x16x32_bf16 v[48:51], v[56:59], v[88:91], v[48:51]
    v_sin_f32 v14, v12
    s_nop 0
    v_mul_f32 v14, v11, v14
    ds_read_b128 v[152:155], v9 offset:2048
    v_mfma_f32_16x16x32_bf16 v[52:55], v[60:63], v[88:91], v[52:55]
    v_mul_f32 v192, v11, v13
    v_mul_f32 v197, v14, v3
    v_mfma_f32_16x16x32_bf16 v[16:19], v[64:67], v[92:95], v[16:19]
    v_mul_f32 v11, 1090519040, v242
    ds_read_b128 v[156:159], v9 offset:4096
    v_mfma_f32_16x16x32_bf16 v[20:23], v[68:71], v[92:95], v[20:23]
    v_mul_f32 v12, 1090519040, v243
    v_exp_f32 v11, v11
    v_mfma_f32_16x16x32_bf16 v[24:27], v[64:67], v[96:99], v[24:27]
    ds_read_b128 v[160:163], v9 offset:6144
    v_fract_f32 v12, v12
    v_cos_f32 v13, v12
    v_mfma_f32_16x16x32_bf16 v[28:31], v[68:71], v[96:99], v[28:31]
    v_sin_f32 v14, v12
    ds_read_b128 v[164:167], v9 offset:8192
    v_mfma_f32_16x16x32_bf16 v[32:35], v[64:67], v[100:103], v[32:35]
    v_mul_f32 v14, v11, v14
    v_mul_f32 v199, v11, v13
    v_mfma_f32_16x16x32_bf16 v[36:39], v[68:71], v[100:103], v[36:39]
    v_mul_f32 v201, v14, v3
    v_add_u32 v4, 4294850560, v4
    v_add_u32 v5, 4294850560, v5
    v_add_u32 v6, 4294850560, v6
    v_add_u32 v7, 4294850560, v7
    v_add_u32 v8, 4294850560, v8
    v_add_u32 v9, 4294850560, v9
    v_mfma_f32_16x16x32_bf16 v[40:43], v[64:67], v[104:107], v[40:43]
    v_mul_f32 v11, 1124073472, v242
    v_mul_f32 v12, 1124073472, v243
    v_mfma_f32_16x16x32_bf16 v[44:47], v[68:71], v[104:107], v[44:47]
    v_mfma_f32_16x16x32_bf16 v[48:51], v[64:67], v[108:111], v[48:51]
    v_mfma_f32_16x16x32_bf16 v[52:55], v[68:71], v[108:111], v[52:55]
    s_waitcnt lgkmcnt(0)
    s_waitcnt vmcnt(5)
    s_barrier
    v_mfma_f32_16x16x32_bf16 v[206:209], v[112:115], v[222:225], v[206:209]
    ds_read_b128 v[56:59], v4
    v_exp_f32 v11, v11
    v_fract_f32 v12, v12
    v_mfma_f32_16x16x32_bf16 v[214:217], v[112:115], v[112:115], v[214:217]
    v_cos_f32 v13, v12
    ds_read_b128 v[60:63], v6
    v_mfma_f32_16x16x32_bf16 v[210:213], v[116:119], v[222:225], v[210:213]
    v_sin_f32 v14, v12
    s_nop 0
    v_mul_f32 v14, v11, v14
    v_mfma_f32_16x16x32_bf16 v[218:221], v[116:119], v[116:119], v[218:221]
    ds_read_b128 v[72:75], v8 offset:0
    v_mul_f32 v254, v11, v13
    v_mfma_f32_16x16x32_bf16 v[206:209], v[120:123], v[222:225], v[206:209]
    v_mul_f32 v255, v14, v3
    v_lshlrev_b32 v202, 16, v202
    v_mfma_f32_16x16x32_bf16 v[214:217], v[120:123], v[120:123], v[214:217]
    ds_read_b128 v[76:79], v8 offset:2048
    v_lshlrev_b32 v204, 16, v204
    v_mfma_f32_16x16x32_bf16 v[210:213], v[124:127], v[222:225], v[210:213]
    v_lshlrev_b32 v11, 16, v203
    ds_read_b128 v[80:83], v8 offset:4096
    v_mfma_f32_16x16x32_bf16 v[218:221], v[124:127], v[124:127], v[218:221]
    v_mul_f32 v11, s20, v11
    v_exp_f32 v11, v11
    v_mfma_f32_16x16x32_bf16 v[16:19], v[112:115], v[128:131], v[16:19]
    v_cvt_pk_bf16_f32 v11, 0, v11
    ds_read_b128 v[84:87], v8 offset:6144
    v_mfma_f32_16x16x32_bf16 v[20:23], v[116:119], v[128:131], v[20:23]
    v_mul_f32 v12, v11, v202
    v_mul_f32 v13, v11, v204
    v_mfma_f32_16x16x32_bf16 v[24:27], v[112:115], v[132:135], v[24:27]
    ds_read_b128 v[88:91], v8 offset:8192
    v_mul_f32 v242, s20, v12
    v_mfma_f32_16x16x32_bf16 v[28:31], v[116:119], v[132:135], v[28:31]
    v_mul_f32 v243, s21, v13
    v_mul_f32 v11, 1090519040, v242
    v_mfma_f32_16x16x32_bf16 v[32:35], v[112:115], v[136:139], v[32:35]
    ds_read_b128 v[64:67], v5
    v_mul_f32 v12, 1090519040, v243
    v_exp_f32 v11, v11
    v_mfma_f32_16x16x32_bf16 v[36:39], v[116:119], v[136:139], v[36:39]
    ds_read_b128 v[68:71], v7
    v_fract_f32 v12, v12
    v_mfma_f32_16x16x32_bf16 v[40:43], v[112:115], v[140:143], v[40:43]
    v_cos_f32 v13, v12
    v_sin_f32 v14, v12
    v_mfma_f32_16x16x32_bf16 v[44:47], v[116:119], v[140:143], v[44:47]
    ds_read_b128 v[92:95], v9 offset:0
    v_mul_f32 v14, v11, v14
    v_mfma_f32_16x16x32_bf16 v[48:51], v[112:115], v[144:147], v[48:51]
    v_mul_f32 v198, v11, v13
    ds_read_b128 v[96:99], v9 offset:2048
    v_mfma_f32_16x16x32_bf16 v[52:55], v[116:119], v[144:147], v[52:55]
    v_mul_f32 v200, v14, v3
    v_mul_f32 v11, 1124073472, v242
    v_mfma_f32_16x16x32_bf16 v[16:19], v[120:123], v[148:151], v[16:19]
    v_mul_f32 v12, 1124073472, v243
    ds_read_b128 v[100:103], v9 offset:4096
    v_mfma_f32_16x16x32_bf16 v[20:23], v[124:127], v[148:151], v[20:23]
    v_exp_f32 v11, v11
    v_fract_f32 v12, v12
    v_mfma_f32_16x16x32_bf16 v[24:27], v[120:123], v[152:155], v[24:27]
    ds_read_b128 v[104:107], v9 offset:6144
    v_cos_f32 v13, v12
    v_mfma_f32_16x16x32_bf16 v[28:31], v[124:127], v[152:155], v[28:31]
    v_sin_f32 v14, v12
    s_nop 0
    v_mul_f32 v14, v11, v14
    v_mfma_f32_16x16x32_bf16 v[32:35], v[120:123], v[156:159], v[32:35]
    ds_read_b128 v[108:111], v9 offset:8192
    v_mul_f32 v202, v11, v13
    v_mfma_f32_16x16x32_bf16 v[36:39], v[124:127], v[156:159], v[36:39]
    v_mul_f32 v204, v14, v3
    v_add_u32 v4, 38912, v4
    v_add_u32 v5, 38912, v5
    v_add_u32 v6, 38912, v6
    v_add_u32 v7, 38912, v7
    v_add_u32 v8, 38912, v8
    v_add_u32 v9, 38912, v9
    v_mfma_f32_16x16x32_bf16 v[40:43], v[120:123], v[160:163], v[40:43]
    v_mov_b32 v203, v254
    v_mov_b32 v205, v255
    v_mfma_f32_16x16x32_bf16 v[44:47], v[124:127], v[160:163], v[44:47]
    v_mfma_f32_16x16x32_bf16 v[48:51], v[120:123], v[164:167], v[48:51]
    v_mfma_f32_16x16x32_bf16 v[52:55], v[124:127], v[164:167], v[52:55]
    s_waitcnt lgkmcnt(0)
    s_waitcnt vmcnt(0)
    s_barrier
    v_mfma_f32_16x16x32_bf16 v[206:209], v[56:59], v[222:225], v[206:209]
    ds_read_b128 v[112:115], v4
    v_mfma_f32_16x16x32_bf16 v[214:217], v[56:59], v[56:59], v[214:217]
    s_lshl_b32 s36, s32, 7
    s_add_u32 s36, s36, 20480
    v_mov_b32 v15, s36
    buffer_load_dword v15, v15, s[48:51], 0 offen sc1
    v_mfma_f32_16x16x32_bf16 v[210:213], v[60:63], v[222:225], v[210:213]
    v_mfma_f32_16x16x32_bf16 v[218:221], v[60:63], v[60:63], v[218:221]
    ds_read_b128 v[116:119], v6
    v_mfma_f32_16x16x32_bf16 v[206:209], v[64:67], v[222:225], v[206:209]
    ds_read_b128 v[128:131], v8 offset:0
    v_mfma_f32_16x16x32_bf16 v[214:217], v[64:67], v[64:67], v[214:217]
    v_mfma_f32_16x16x32_bf16 v[210:213], v[68:71], v[222:225], v[210:213]
    ds_read_b128 v[132:135], v8 offset:2048
    v_mfma_f32_16x16x32_bf16 v[218:221], v[68:71], v[68:71], v[218:221]
    ds_read_b128 v[136:139], v8 offset:4096
    v_mfma_f32_16x16x32_bf16 v[16:19], v[56:59], v[72:75], v[16:19]
    v_mfma_f32_16x16x32_bf16 v[20:23], v[60:63], v[72:75], v[20:23]
    ds_read_b128 v[140:143], v8 offset:6144
    v_mfma_f32_16x16x32_bf16 v[24:27], v[56:59], v[76:79], v[24:27]
    ds_read_b128 v[144:147], v8 offset:8192
    v_mfma_f32_16x16x32_bf16 v[28:31], v[60:63], v[76:79], v[28:31]
    v_mfma_f32_16x16x32_bf16 v[32:35], v[56:59], v[80:83], v[32:35]
    ds_read_b128 v[120:123], v5
    v_mfma_f32_16x16x32_bf16 v[36:39], v[60:63], v[80:83], v[36:39]
    v_mfma_f32_16x16x32_bf16 v[40:43], v[56:59], v[84:87], v[40:43]
    ds_read_b128 v[124:127], v7
    v_mfma_f32_16x16x32_bf16 v[44:47], v[60:63], v[84:87], v[44:47]
    ds_read_b128 v[148:151], v9 offset:0
    v_mfma_f32_16x16x32_bf16 v[48:51], v[56:59], v[88:91], v[48:51]
    v_mfma_f32_16x16x32_bf16 v[52:55], v[60:63], v[88:91], v[52:55]
    ds_read_b128 v[152:155], v9 offset:2048
    v_mfma_f32_16x16x32_bf16 v[16:19], v[64:67], v[92:95], v[16:19]
    ds_read_b128 v[156:159], v9 offset:4096
    v_mfma_f32_16x16x32_bf16 v[20:23], v[68:71], v[92:95], v[20:23]
    v_mfma_f32_16x16x32_bf16 v[24:27], v[64:67], v[96:99], v[24:27]
    ds_read_b128 v[160:163], v9 offset:6144
    v_mfma_f32_16x16x32_bf16 v[28:31], v[68:71], v[96:99], v[28:31]
    ds_read_b128 v[164:167], v9 offset:8192
    v_mfma_f32_16x16x32_bf16 v[32:35], v[64:67], v[100:103], v[32:35]
    v_mfma_f32_16x16x32_bf16 v[36:39], v[68:71], v[100:103], v[36:39]
    v_add_u32 v4, 38912, v4
    v_add_u32 v5, 38912, v5
    v_add_u32 v6, 38912, v6
    v_add_u32 v7, 38912, v7
    v_add_u32 v8, 38912, v8
    v_add_u32 v9, 38912, v9
    v_mfma_f32_16x16x32_bf16 v[40:43], v[64:67], v[104:107], v[40:43]
    v_mfma_f32_16x16x32_bf16 v[44:47], v[68:71], v[104:107], v[44:47]
    v_mfma_f32_16x16x32_bf16 v[48:51], v[64:67], v[108:111], v[48:51]
    v_mfma_f32_16x16x32_bf16 v[52:55], v[68:71], v[108:111], v[52:55]
    s_waitcnt lgkmcnt(0)
    v_mfma_f32_16x16x32_bf16 v[206:209], v[112:115], v[222:225], v[206:209]
    v_mfma_f32_16x16x32_bf16 v[214:217], v[112:115], v[112:115], v[214:217]
    v_mfma_f32_16x16x32_bf16 v[210:213], v[116:119], v[222:225], v[210:213]
    v_mfma_f32_16x16x32_bf16 v[218:221], v[116:119], v[116:119], v[218:221]
    v_mfma_f32_16x16x32_bf16 v[206:209], v[120:123], v[222:225], v[206:209]
    v_mfma_f32_16x16x32_bf16 v[214:217], v[120:123], v[120:123], v[214:217]
    v_mfma_f32_16x16x32_bf16 v[210:213], v[124:127], v[222:225], v[210:213]
    v_mfma_f32_16x16x32_bf16 v[218:221], v[124:127], v[124:127], v[218:221]
    v_lshlrev_b32 v12, 2, v2
    v_mfma_f32_16x16x32_bf16 v[16:19], v[112:115], v[128:131], v[16:19]
    v_mfma_f32_16x16x32_bf16 v[20:23], v[116:119], v[128:131], v[20:23]
    v_mfma_f32_16x16x32_bf16 v[24:27], v[112:115], v[132:135], v[24:27]
    v_mfma_f32_16x16x32_bf16 v[28:31], v[116:119], v[132:135], v[28:31]
    v_mfma_f32_16x16x32_bf16 v[32:35], v[112:115], v[136:139], v[32:35]
    ds_bpermute_b32 v214, v10, v214 offset:0
    ds_bpermute_b32 v215, v10, v215 offset:4
    ds_bpermute_b32 v216, v10, v216 offset:8
    ds_bpermute_b32 v217, v10, v217 offset:12
    ds_bpermute_b32 v218, v10, v218 offset:0
    ds_bpermute_b32 v219, v10, v219 offset:4
    ds_bpermute_b32 v220, v10, v220 offset:8
    ds_bpermute_b32 v221, v10, v221 offset:12
    v_mfma_f32_16x16x32_bf16 v[36:39], v[116:119], v[136:139], v[36:39]
    v_mfma_f32_16x16x32_bf16 v[40:43], v[112:115], v[140:143], v[40:43]
    v_mfma_f32_16x16x32_bf16 v[44:47], v[116:119], v[140:143], v[44:47]
    v_mfma_f32_16x16x32_bf16 v[48:51], v[112:115], v[144:147], v[48:51]
    s_waitcnt lgkmcnt(0)
    v_mfma_f32_16x16x32_bf16 v[52:55], v[116:119], v[144:147], v[52:55]
    v_mul_f32 v206, 986500301, v206
    v_mul_f32 v207, 986500301, v207
    v_mul_f32 v208, 986500301, v208
    v_mul_f32 v209, 986500301, v209
    v_mul_f32 v210, 986500301, v210
    v_mul_f32 v211, 986500301, v211
    v_mul_f32 v212, 986500301, v212
    v_mul_f32 v213, 986500301, v213
    v_mul_f32 v214, 986500301, v214
    v_mul_f32 v215, 986500301, v215
    v_mul_f32 v216, 986500301, v216
    v_mfma_f32_16x16x32_bf16 v[16:19], v[120:123], v[148:151], v[16:19]
    v_mul_f32 v217, 986500301, v217
    v_mul_f32 v218, 986500301, v218
    v_mul_f32 v219, 986500301, v219
    v_mul_f32 v220, 986500301, v220
    v_mul_f32 v221, 986500301, v221
    v_fma_f32 v214, -v206, v206, v214
    v_fma_f32 v215, -v207, v207, v215
    v_fma_f32 v216, -v208, v208, v216
    v_fma_f32 v217, -v209, v209, v217
    v_fma_f32 v218, -v210, v210, v218
    v_mfma_f32_16x16x32_bf16 v[20:23], v[124:127], v[148:151], v[20:23]
    v_fma_f32 v219, -v211, v211, v219
    v_fma_f32 v220, -v212, v212, v220
    v_fma_f32 v221, -v213, v213, v221
    v_max_f32 v214, 0, v214
    v_max_f32 v215, 0, v215
    v_max_f32 v216, 0, v216
    v_max_f32 v217, 0, v217
    v_max_f32 v218, 0, v218
    v_max_f32 v219, 0, v219
    v_max_f32 v220, 0, v220
    v_mfma_f32_16x16x32_bf16 v[24:27], v[120:123], v[152:155], v[24:27]
    v_max_f32 v221, 0, v221
    v_cvt_pk_bf16_f32 v206, 0, v206
    v_cvt_pk_bf16_f32 v207, 0, v207
    v_cvt_pk_bf16_f32 v208, 0, v208
    v_cvt_pk_bf16_f32 v209, 0, v209
    v_cvt_pk_bf16_f32 v210, 0, v210
    v_cvt_pk_bf16_f32 v211, 0, v211
    v_cvt_pk_bf16_f32 v212, 0, v212
    v_cvt_pk_bf16_f32 v213, 0, v213
    s_lshl_b32 s36, s35, 7
    v_mfma_f32_16x16x32_bf16 v[28:31], v[124:127], v[152:155], v[28:31]
    v_lshlrev_b32 v13, 5, v1
    v_add_u32 v13, s36, v13
    v_add_u32 v14, 161280, v13
    s_mul_i32 s36, s35, 1280
    v_mul_u32_u24 v6, 320, v1
    v_add3_u32 v6, v6, v12, s36
    v_add_u32 v7, 155648, v6
    v_lshlrev_b32 v8, 2, v0
    v_add_u32 v9, 155648, v8
    v_mov_b32 v10, v12
    v_mfma_f32_16x16x32_bf16 v[32:35], v[120:123], v[156:159], v[32:35]
    v_add_u32 v11, 155904, v10
    s_lshl_b32 s38, s35, 2
    s_add_u32 s38, s38, 161168
    v_add_u32 v13, 162304, v12
    v_cvt_pk_bf16_f32 v214, 0, v214
    v_cvt_pk_bf16_f32 v215, 0, v215
    v_cvt_pk_bf16_f32 v216, 0, v216
    v_cvt_pk_bf16_f32 v217, 0, v217
    v_cvt_pk_bf16_f32 v218, 0, v218
    v_cvt_pk_bf16_f32 v219, 0, v219
    v_mfma_f32_16x16x32_bf16 v[36:39], v[124:127], v[156:159], v[36:39]
    v_cvt_pk_bf16_f32 v220, 0, v220
    v_cvt_pk_bf16_f32 v221, 0, v221
    v_add_f32 v214, 925353388, v214
    v_add_f32 v215, 925353388, v215
    v_add_f32 v216, 925353388, v216
    v_add_f32 v217, 925353388, v217
    v_add_f32 v218, 925353388, v218
    v_add_f32 v219, 925353388, v219
    v_add_f32 v220, 925353388, v220
    v_add_f32 v221, 925353388, v221
    v_mfma_f32_16x16x32_bf16 v[40:43], v[120:123], v[160:163], v[40:43]
    v_cvt_pk_bf16_f32 v214, 0, v214
    v_cvt_pk_bf16_f32 v215, 0, v215
    v_cvt_pk_bf16_f32 v216, 0, v216
    v_cvt_pk_bf16_f32 v217, 0, v217
    v_cvt_pk_bf16_f32 v218, 0, v218
    v_cvt_pk_bf16_f32 v219, 0, v219
    v_cvt_pk_bf16_f32 v220, 0, v220
    v_cvt_pk_bf16_f32 v221, 0, v221
    v_sqrt_f32 v214, v214
    v_sqrt_f32 v215, v215
    v_mfma_f32_16x16x32_bf16 v[44:47], v[124:127], v[160:163], v[44:47]
    v_sqrt_f32 v216, v216
    v_sqrt_f32 v217, v217
    v_sqrt_f32 v218, v218
    v_sqrt_f32 v219, v219
    v_sqrt_f32 v220, v220
    v_sqrt_f32 v221, v221
    v_cvt_pk_bf16_f32 v214, 0, v214
    v_cvt_pk_bf16_f32 v215, 0, v215
    v_cvt_pk_bf16_f32 v216, 0, v216
    v_cvt_pk_bf16_f32 v217, 0, v217
    v_mfma_f32_16x16x32_bf16 v[48:51], v[120:123], v[164:167], v[48:51]
    v_cvt_pk_bf16_f32 v218, 0, v218
    v_cvt_pk_bf16_f32 v219, 0, v219
    v_cvt_pk_bf16_f32 v220, 0, v220
    v_cvt_pk_bf16_f32 v221, 0, v221
    v_rcp_f32 v234, v214
    v_rcp_f32 v235, v215
    v_rcp_f32 v236, v216
    v_rcp_f32 v237, v217
    v_rcp_f32 v238, v218
    v_rcp_f32 v239, v219
    v_mfma_f32_16x16x32_bf16 v[52:55], v[124:127], v[164:167], v[52:55]
    v_rcp_f32 v240, v220
    v_rcp_f32 v241, v221
    v_mul_f32 v226, v206, v234
    v_mul_f32 v227, v207, v235
    v_mul_f32 v228, v208, v236
    v_mul_f32 v229, v209, v237
    v_mul_f32 v230, v210, v238
    v_mul_f32 v231, v211, v239
    v_mul_f32 v232, v212, v240
    v_mul_f32 v233, v213, v241
    v_mov_b32 v4, 161156
    s_mov_b32 s39, 0
L_kf_kernel_e0:
    ds_read_b32 v5, v4
    s_waitcnt lgkmcnt(0)
    v_readfirstlane_b32 s36, v5
    s_add_u32 s39, s39, 1
    s_cmp_eq_u32 s36, 4
    s_cbranch_scc1 L_kf_kernel_e0d
    s_sleep 1
    s_cmp_lt_u32 s39, 0x400000
    s_cbranch_scc1 L_kf_kernel_e0
L_kf_kernel_e0d:
    s_setprio 2
    ds_read_b32 v72, v13 offset:0
    ds_read_b32 v73, v13 offset:64
    ds_read_b32 v74, v13 offset:128
    ds_read_b32 v75, v13 offset:192
    ds_read_b32 v76, v13 offset:256
    ds_read_b32 v77, v13 offset:320
    ds_read_b32 v78, v13 offset:384
    ds_read_b32 v79, v13 offset:448
    ds_read_b32 v80, v13 offset:512
    ds_read_b32 v81, v13 offset:576
    ds_read_b32 v82, v13 offset:640
    ds_read_b32 v83, v13 offset:704
    ds_read_b32 v84, v13 offset:768
    ds_read_b32 v85, v13 offset:832
    ds_read_b32 v86, v13 offset:896
    ds_read_b32 v87, v13 offset:960
    ds_read_b32 v88, v13 offset:1024
    ds_read_b32 v89, v13 offset:1088
    ds_read_b32 v90, v13 offset:1152
    ds_read_b32 v91, v13 offset:1216
    s_mov_b32 exec_lo, 0x00010001
    s_mov_b32 exec_hi, 0x00010001
    ds_write_b128 v14, v[226:229] offset:0
    ds_write_b128 v14, v[234:237] offset:512
    ds_write_b128 v14, v[230:233] offset:16
    ds_write_b128 v14, v[238:241] offset:528
    v_mov_b32 v4, s38
    v_mov_b32 v5, 1
    s_mov_b64 exec, 1
    ds_add_u32 v4, v5
    s_mov_b64 exec, -1
    v_mul_f32 v16, v16, v234
    v_mul_f32 v17, v17, v235
    v_mul_f32 v24, v24, v234
    v_mul_f32 v25, v25, v235
    v_mul_f32 v32, v32, v234
    v_mul_f32 v33, v33, v235
    v_mul_f32 v40, v40, v234
    v_mul_f32 v41, v41, v235
    v_mul_f32 v48, v48, v234
    v_mul_f32 v49, v49, v235
    v_mul_f32 v18, v18, v236
    v_mul_f32 v19, v19, v237
    v_mul_f32 v26, v26, v236
    v_mul_f32 v27, v27, v237
    v_mul_f32 v34, v34, v236
    v_mul_f32 v35, v35, v237
    v_mul_f32 v42, v42, v236
    v_mul_f32 v43, v43, v237
    v_mul_f32 v50, v50, v236
    v_mul_f32 v51, v51, v237
    v_mul_f32 v20, v20, v238
    v_mul_f32 v21, v21, v239
    v_mul_f32 v28, v28, v238
    v_mul_f32 v29, v29, v239
    v_mul_f32 v36, v36, v238
    v_mul_f32 v37, v37, v239
    v_mul_f32 v44, v44, v238
    v_mul_f32 v45, v45, v239
    v_mul_f32 v52, v52, v238
    v_mul_f32 v53, v53, v239
    v_mul_f32 v22, v22, v240
    v_mul_f32 v23, v23, v241
    v_mul_f32 v30, v30, v240
    v_mul_f32 v31, v31, v241
    v_mul_f32 v38, v38, v240
    v_mul_f32 v39, v39, v241
    v_mul_f32 v46, v46, v240
    v_mul_f32 v47, v47, v241
    v_mul_f32 v54, v54, v240
    v_mul_f32 v55, v55, v241
    s_waitcnt lgkmcnt(5)
    v_add_f32 v72, v72, v77
    v_add_f32 v82, v82, v87
    v_add_f32 v73, v73, v78
    v_add_f32 v83, v83, v88
    v_add_f32 v74, v74, v79
    v_add_f32 v84, v84, v89
    v_add_f32 v75, v75, v80
    v_add_f32 v85, v85, v90
    v_add_f32 v76, v76, v81
    v_add_f32 v86, v86, v91
    v_add_f32 v72, v72, v82
    v_add_f32 v73, v73, v83
    v_add_f32 v74, v74, v84
    v_add_f32 v75, v75, v85
    v_add_f32 v76, v76, v86
    v_fma_f32 v16, -v226, v72, v16
    v_fma_f32 v24, -v226, v73, v24
    v_fma_f32 v32, -v226, v74, v32
    v_fma_f32 v40, -v226, v75, v40
    v_fma_f32 v48, -v226, v76, v48
    v_fma_f32 v17, -v227, v72, v17
    v_fma_f32 v25, -v227, v73, v25
    v_fma_f32 v33, -v227, v74, v33
    v_fma_f32 v41, -v227, v75, v41
    v_fma_f32 v49, -v227, v76, v49
    v_fma_f32 v96, v168, v16, v17
    v_fma_f32 v97, v169, v24, v25
    v_fma_f32 v98, v170, v32, v33
    v_fma_f32 v99, v171, v40, v41
    v_fma_f32 v100, v172, v48, v49
    v_fmac_f32_dpp v96, v16, v173 row_ror:8 row_mask:0xf bank_mask:0xf
    v_fmac_f32_dpp v97, v24, v174 row_ror:8 row_mask:0xf bank_mask:0xf
    v_fmac_f32_dpp v98, v32, v175 row_ror:8 row_mask:0xf bank_mask:0xf
    v_fmac_f32_dpp v99, v40, v176 row_ror:8 row_mask:0xf bank_mask:0xf
    v_fmac_f32_dpp v100, v48, v177 row_ror:8 row_mask:0xf bank_mask:0xf
    v_fma_f32 v18, -v228, v72, v18
    v_fma_f32 v26, -v228, v73, v26
    v_fma_f32 v34, -v228, v74, v34
    v_fma_f32 v42, -v228, v75, v42
    v_fma_f32 v50, -v228, v76, v50
    v_fma_f32 v101, v168, v96, v18
    v_fma_f32 v102, v169, v97, v26
    v_fma_f32 v103, v170, v98, v34
    v_fma_f32 v104, v171, v99, v42
    v_fma_f32 v105, v172, v100, v50
    v_fmac_f32_dpp v101, v96, v173 row_ror:8 row_mask:0xf bank_mask:0xf
    v_fmac_f32_dpp v102, v97, v174 row_ror:8 row_mask:0xf bank_mask:0xf
    v_fmac_f32_dpp v103, v98, v175 row_ror:8 row_mask:0xf bank_mask:0xf
    v_fmac_f32_dpp v104, v99, v176 row_ror:8 row_mask:0xf bank_mask:0xf
    v_fmac_f32_dpp v105, v100, v177 row_ror:8 row_mask:0xf bank_mask:0xf
    v_fma_f32 v19, -v229, v72, v19
    v_fma_f32 v27, -v229, v73, v27
    v_fma_f32 v35, -v229, v74, v35
    v_fma_f32 v43, -v229, v75, v43
    v_fma_f32 v51, -v229, v76, v51
    v_fma_f32 v96, v168, v101, v19
    v_fma_f32 v97, v169, v102, v27
    v_fma_f32 v98, v170, v103, v35
    v_fma_f32 v99, v171, v104, v43
    v_fma_f32 v100, v172, v105, v51
    v_fmac_f32_dpp v96, v101, v173 row_ror:8 row_mask:0xf bank_mask:0xf
    v_fmac_f32_dpp v97, v102, v174 row_ror:8 row_mask:0xf bank_mask:0xf
    v_fmac_f32_dpp v98, v103, v175 row_ror:8 row_mask:0xf bank_mask:0xf
    v_fmac_f32_dpp v99, v104, v176 row_ror:8 row_mask:0xf bank_mask:0xf
    v_fmac_f32_dpp v100, v105, v177 row_ror:8 row_mask:0xf bank_mask:0xf
    v_fma_f32 v20, -v230, v72, v20
    v_fma_f32 v28, -v230, v73, v28
    v_fma_f32 v36, -v230, v74, v36
    v_fma_f32 v44, -v230, v75, v44
    v_fma_f32 v52, -v230, v76, v52
    v_fma_f32 v101, v168, v96, v20
    v_fma_f32 v102, v169, v97, v28
    v_fma_f32 v103, v170, v98, v36
    v_fma_f32 v104, v171, v99, v44
    v_fma_f32 v105, v172, v100, v52
    v_fmac_f32_dpp v101, v96, v173 row_ror:8 row_mask:0xf bank_mask:0xf
    v_fmac_f32_dpp v102, v97, v174 row_ror:8 row_mask:0xf bank_mask:0xf
    v_fmac_f32_dpp v103, v98, v175 row_ror:8 row_mask:0xf bank_mask:0xf
    v_fmac_f32_dpp v104, v99, v176 row_ror:8 row_mask:0xf bank_mask:0xf
    v_fmac_f32_dpp v105, v100, v177 row_ror:8 row_mask:0xf bank_mask:0xf
    v_fma_f32 v21, -v231, v72, v21
    v_fma_f32 v29, -v231, v73, v29
    v_fma_f32 v37, -v231, v74, v37
    v_fma_f32 v45, -v231, v75, v45
    v_fma_f32 v53, -v231, v76, v53
    v_fma_f32 v96, v168, v101, v21
    v_fma_f32 v97, v169, v102, v29
    v_fma_f32 v98, v170, v103, v37
    v_fma_f32 v99, v171, v104, v45
    v_fma_f32 v100, v172, v105, v53
    v_fmac_f32_dpp v96, v101, v173 row_ror:8 row_mask:0xf bank_mask:0xf
    v_fmac_f32_dpp v97, v102, v174 row_ror:8 row_mask:0xf bank_mask:0xf
    v_fmac_f32_dpp v98, v103, v175 row_ror:8 row_mask:0xf bank_mask:0xf
    v_fmac_f32_dpp v99, v104, v176 row_ror:8 row_mask:0xf bank_mask:0xf
    v_fmac_f32_dpp v100, v105, v177 row_ror:8 row_mask:0xf bank_mask:0xf
    v_fma_f32 v22, -v232, v72, v22
    v_fma_f32 v30, -v232, v73, v30
    v_fma_f32 v38, -v232, v74, v38
    v_fma_f32 v46, -v232, v75, v46
    v_fma_f32 v54, -v232, v76, v54
    v_fma_f32 v101, v168, v96, v22
    v_fma_f32 v102, v169, v97, v30
    v_fma_f32 v103, v170, v98, v38
    v_fma_f32 v104, v171, v99, v46
    v_fma_f32 v105, v172, v100, v54
    v_fmac_f32_dpp v101, v96, v173 row_ror:8 row_mask:0xf bank_mask:0xf
    v_fmac_f32_dpp v102, v97, v174 row_ror:8 row_mask:0xf bank_mask:0xf
    v_fmac_f32_dpp v103, v98, v175 row_ror:8 row_mask:0xf bank_mask:0xf
    v_fmac_f32_dpp v104, v99, v176 row_ror:8 row_mask:0xf bank_mask:0xf
    v_fmac_f32_dpp v105, v100, v177 row_ror:8 row_mask:0xf bank_mask:0xf
    v_fma_f32 v23, -v233, v72, v23
    v_fma_f32 v31, -v233, v73, v31
    v_fma_f32 v39, -v233, v74, v39
    v_fma_f32 v47, -v233, v75, v47
    v_fma_f32 v55, -v233, v76, v55
    v_fma_f32 v96, v168, v101, v23
    v_fma_f32 v97, v169, v102, v31
    v_fma_f32 v98, v170, v103, v39
    v_fma_f32 v99, v171, v104, v47
    v_fma_f32 v100, v172, v105, v55
    v_fmac_f32_dpp v96, v101, v173 row_ror:8 row_mask:0xf bank_mask:0xf
    v_fmac_f32_dpp v97, v102, v174 row_ror:8 row_mask:0xf bank_mask:0xf
    v_fmac_f32_dpp v98, v103, v175 row_ror:8 row_mask:0xf bank_mask:0xf
    v_fmac_f32_dpp v99, v104, v176 row_ror:8 row_mask:0xf bank_mask:0xf
    v_fmac_f32_dpp v100, v105, v177 row_ror:8 row_mask:0xf bank_mask:0xf
    ds_write_b32 v7, v96 offset:0
    ds_write_b32 v7, v97 offset:64
    ds_write_b32 v7, v98 offset:128
    ds_write_b32 v7, v99 offset:192
    ds_write_b32 v7, v100 offset:256
    v_mov_b32 v4, 161152
    v_mov_b32 v5, 1
    s_mov_b64 exec, 1
    ds_add_u32 v4, v5
    s_mov_b64 exec, -1
    s_waitcnt vmcnt(0)
    v_mov_b32 v4, 161152
    s_mov_b32 s39, 0
L_kf_kernel_x1:
    ds_read_b32 v5, v4
    s_waitcnt lgkmcnt(0)
    v_readfirstlane_b32 s36, v5
    s_add_u32 s39, s39, 1
    s_cmp_eq_u32 s36, 4
    s_cbranch_scc1 L_kf_kernel_x1d
    s_sleep 1
    s_cmp_lt_u32 s39, 0x400000
    s_cbranch_scc1 L_kf_kernel_x1
L_kf_kernel_x1d:
    ds_read_b32 v112, v9 offset:0
    ds_read_b32 v128, v11 offset:0
    ds_read_b32 v113, v9 offset:320
    ds_read_b32 v129, v11 offset:320
    ds_read_b32 v114, v9 offset:640
    ds_read_b32 v130, v11 offset:640
    ds_read_b32 v115, v9 offset:960
    ds_read_b32 v131, v11 offset:960
    ds_read_b32 v116, v9 offset:1280
    ds_read_b32 v132, v11 offset:1280
    ds_read_b32 v117, v9 offset:1600
    ds_read_b32 v133, v11 offset:1600
    ds_read_b32 v118, v9 offset:1920
    ds_read_b32 v134, v11 offset:1920
    ds_read_b32 v119, v9 offset:2240
    ds_read_b32 v135, v11 offset:2240
    ds_read_b32 v120, v9 offset:2560
    ds_read_b32 v136, v11 offset:2560
    ds_read_b32 v121, v9 offset:2880
    ds_read_b32 v137, v11 offset:2880
    ds_read_b32 v122, v9 offset:3200
    ds_read_b32 v138, v11 offset:3200
    ds_read_b32 v123, v9 offset:3520
    ds_read_b32 v139, v11 offset:3520
    ds_read_b32 v124, v9 offset:3840
    ds_read_b32 v140, v11 offset:3840
    ds_read_b32 v125, v9 offset:4160
    ds_read_b32 v141, v11 offset:4160
    ds_read_b32 v126, v9 offset:4480
    ds_read_b32 v142, v11 offset:4480
    ds_read_b32 v127, v9 offset:4800
    ds_read_b32 v143, v11 offset:4800
    v_lshlrev_b32 v4, 3, v0
    v_lshlrev_b32 v5, 3, v2
    v_mov_b32 v147, 1511506921
    v_mov_b32 v149, 1511506921
    s_add_u32 s37, s32, 15
    s_mul_i32 s37, s37, 640
    s_waitcnt lgkmcnt(15)
    v_fmac_f32 v113, v198, v112
    v_fmac_f32 v129, v199, v128
    s_nop 0
    v_fmac_f32_dpp v113, v112, v200 row_ror:8 row_mask:0xf bank_mask:0xf
    v_fmac_f32_dpp v129, v128, v201 row_ror:8 row_mask:0xf bank_mask:0xf
    v_fmac_f32 v114, v198, v113
    v_fmac_f32 v130, v199, v129
    s_nop 0
    v_fmac_f32_dpp v114, v113, v200 row_ror:8 row_mask:0xf bank_mask:0xf
    v_fmac_f32_dpp v130, v129, v201 row_ror:8 row_mask:0xf bank_mask:0xf
    v_fmac_f32 v115, v198, v114
    v_fmac_f32 v131, v199, v130
    s_nop 0
    v_fmac_f32_dpp v115, v114, v200 row_ror:8 row_mask:0xf bank_mask:0xf
    v_fmac_f32_dpp v131, v130, v201 row_ror:8 row_mask:0xf bank_mask:0xf
    v_fmac_f32 v116, v198, v115
    v_fmac_f32 v132, v199, v131
    s_nop 0
    v_fmac_f32_dpp v116, v115, v200 row_ror:8 row_mask:0xf bank_mask:0xf
    v_fmac_f32_dpp v132, v131, v201 row_ror:8 row_mask:0xf bank_mask:0xf
    v_fmac_f32 v117, v198, v116
    v_fmac_f32 v133, v199, v132
    s_nop 0
    v_fmac_f32_dpp v117, v116, v200 row_ror:8 row_mask:0xf bank_mask:0xf
    v_fmac_f32_dpp v133, v132, v201 row_ror:8 row_mask:0xf bank_mask:0xf
    v_fmac_f32 v118, v198, v117
    v_fmac_f32 v134, v199, v133
    s_nop 0
    v_fmac_f32_dpp v118, v117, v200 row_ror:8 row_mask:0xf bank_mask:0xf
    v_fmac_f32_dpp v134, v133, v201 row_ror:8 row_mask:0xf bank_mask:0xf
    v_fmac_f32 v119, v198, v118
    v_fmac_f32 v135, v199, v134
    s_nop 0
    v_fmac_f32_dpp v119, v118, v200 row_ror:8 row_mask:0xf bank_mask:0xf
    v_fmac_f32_dpp v135, v134, v201 row_ror:8 row_mask:0xf bank_mask:0xf
    s_waitcnt lgkmcnt(14)
    v_fmac_f32 v120, v198, v119
    v_fmac_f32 v136, v199, v135
    s_nop 0
    v_fmac_f32_dpp v120, v119, v200 row_ror:8 row_mask:0xf bank_mask:0xf
    v_fmac_f32_dpp v136, v135, v201 row_ror:8 row_mask:0xf bank_mask:0xf
    s_waitcnt lgkmcnt(12)
    v_fmac_f32 v121, v198, v120
    v_fmac_f32 v137, v199, v136
    s_nop 0
    v_fmac_f32_dpp v121, v120, v200 row_ror:8 row_mask:0xf bank_mask:0xf
    v_fmac_f32_dpp v137, v136, v201 row_ror:8 row_mask:0xf bank_mask:0xf
    s_waitcnt lgkmcnt(10)
    v_fmac_f32 v122, v198, v121
    v_fmac_f32 v138, v199, v137
    s_nop 0
    v_fmac_f32_dpp v122, v121, v200 row_ror:8 row_mask:0xf bank_mask:0xf
    v_fmac_f32_dpp v138, v137, v201 row_ror:8 row_mask:0xf bank_mask:0xf
    s_waitcnt lgkmcnt(8)
    v_fmac_f32 v123, v198, v122
    v_fmac_f32 v139, v199, v138
    s_nop 0
    v_fmac_f32_dpp v123, v122, v200 row_ror:8 row_mask:0xf bank_mask:0xf
    v_fmac_f32_dpp v139, v138, v201 row_ror:8 row_mask:0xf bank_mask:0xf
    s_waitcnt lgkmcnt(6)
    v_fmac_f32 v124, v198, v123
    v_fmac_f32 v140, v199, v139
    s_nop 0
    v_fmac_f32_dpp v124, v123, v200 row_ror:8 row_mask:0xf bank_mask:0xf
    v_fmac_f32_dpp v140, v139, v201 row_ror:8 row_mask:0xf bank_mask:0xf
    s_waitcnt lgkmcnt(4)
    v_fmac_f32 v125, v198, v124
    v_fmac_f32 v141, v199, v140
    s_nop 0
    v_fmac_f32_dpp v125, v124, v200 row_ror:8 row_mask:0xf bank_mask:0xf
    v_fmac_f32_dpp v141, v140, v201 row_ror:8 row_mask:0xf bank_mask:0xf
    s_waitcnt lgkmcnt(2)
    v_fmac_f32 v126, v198, v125
    v_fmac_f32 v142, v199, v141
    s_nop 0
    v_fmac_f32_dpp v126, v125, v200 row_ror:8 row_mask:0xf bank_mask:0xf
    v_fmac_f32_dpp v142, v141, v201 row_ror:8 row_mask:0xf bank_mask:0xf
    s_waitcnt lgkmcnt(0)
    v_fmac_f32 v127, v198, v126
    v_fmac_f32 v143, v199, v142
    s_nop 0
    v_fmac_f32_dpp v127, v126, v200 row_ror:8 row_mask:0xf bank_mask:0xf
    v_fmac_f32_dpp v143, v142, v201 row_ror:8 row_mask:0xf bank_mask:0xf
    s_cmp_lg_u32 s35, 0
    s_cbranch_scc1 L_kf_kernel_nopub
    v_mov_b32 v146, v127
    v_mov_b32 v148, v143
    buffer_store_dwordx2 v[146:147], v4, s[48:51], s37 offen sc1
    buffer_store_dwordx2 v[148:149], v5, s[48:51], s37 offen offset:512 sc1
L_kf_kernel_nopub:
    v_mov_b32 v254, v15
    v_lshlrev_b32 v252, 4, v0
    s_mul_i32 s70, s32, 640
    s_add_u32 s71, s70, 4096
    s_add_u32 s69, s70, 8192
    v_add_u32 v9, 24576, v8
    v_add_u32 v11, 24832, v10
    v_mov_b32 v146, 0
    ds_write_b32 v9, v146
    ds_write_b32 v9, v112 offset:320
    ds_write_b32 v9, v113 offset:640
    ds_write_b32 v9, v114 offset:960
    ds_write_b32 v9, v115 offset:1280
    ds_write_b32 v9, v116 offset:1600
    ds_write_b32 v9, v117 offset:1920
    ds_write_b32 v9, v118 offset:2240
    ds_write_b32 v9, v119 offset:2560
    ds_write_b32 v9, v120 offset:2880
    ds_write_b32 v9, v121 offset:3200
    ds_write_b32 v9, v122 offset:3520
    ds_write_b32 v9, v123 offset:3840
    ds_write_b32 v9, v124 offset:4160
    ds_write_b32 v9, v125 offset:4480
    ds_write_b32 v9, v126 offset:4800
    s_mov_b64 exec, 0xffff
    ds_write_b32 v11, v146
    ds_write_b32 v11, v128 offset:320
    ds_write_b32 v11, v129 offset:640
    ds_write_b32 v11, v130 offset:960
    ds_write_b32 v11, v131 offset:1280
    ds_write_b32 v11, v132 offset:1600
    ds_write_b32 v11, v133 offset:1920
    ds_write_b32 v11, v134 offset:2240
    ds_write_b32 v11, v135 offset:2560
    ds_write_b32 v11, v136 offset:2880
    ds_write_b32 v11, v137 offset:3200
    ds_write_b32 v11, v138 offset:3520
    ds_write_b32 v11, v139 offset:3840
    ds_write_b32 v11, v140 offset:4160
    ds_write_b32 v11, v141 offset:4480
    ds_write_b32 v11, v142 offset:4800
    s_mov_b64 exec, -1
    v_add_u32 v7, 24576, v6
    ds_read_b32 v152, v7 offset:0
    ds_read_b32 v153, v7 offset:64
    ds_read_b32 v154, v7 offset:128
    ds_read_b32 v155, v7 offset:192
    ds_read_b32 v156, v7 offset:256
    v_add_u32 v9, 32768, v8
    v_add_u32 v11, 32768, v10
    s_cmp_lg_u32 s35, 0
    s_cbranch_scc1 L_kf_kernel_hw
    s_cmp_eq_u32 s32, 0
    s_cbranch_scc1 L_kf_kernel_r0
    s_mov_b32 s39, 0
    s_lshl_b32 s38, s32, 7
    s_add_u32 s38, s38, 20480
    v_mov_b32 v14, s38
L_kf_kernel_cl:
    v_readfirstlane_b32 s38, v15
    s_add_u32 s39, s39, 1
    s_cmp_eq_u32 s38, 1511506921
    s_cbranch_scc1 L_kf_kernel_clok
    buffer_load_dword v15, v14, s[48:51], 0 offen sc1
    s_waitcnt vmcnt(0)
    s_cmp_lt_u32 s39, 0x100000
    s_cbranch_scc1 L_kf_kernel_cl
L_kf_kernel_clok:
    v_mov_b32 v254, v15
    buffer_load_dwordx4 v[56:59], v252, s[48:51], s70 offen offset:0 sc1
    buffer_load_dwordx4 v[60:63], v252, s[48:51], s70 offen offset:1024 sc1
    buffer_load_dwordx4 v[64:67], v252, s[48:51], s70 offen offset:2048 sc1
    buffer_load_dwordx4 v[68:71], v252, s[48:51], s70 offen offset:3072 sc1
    buffer_load_dwordx4 v[72:75], v252, s[48:51], s71 offen offset:0 sc1
    buffer_load_dwordx4 v[76:79], v252, s[48:51], s71 offen offset:1024 sc1
    buffer_load_dwordx4 v[80:83], v252, s[48:51], s71 offen offset:2048 sc1
    buffer_load_dwordx4 v[84:87], v252, s[48:51], s71 offen offset:3072 sc1
    buffer_load_dwordx4 v[88:91], v252, s[48:51], s69 offen offset:0 sc1
    buffer_load_dwordx4 v[92:95], v252, s[48:51], s69 offen offset:1024 sc1
    v_mov_b32 v12, 161160
    s_mov_b32 s39, 0
L_kf_kernel_m9:
    ds_read_b32 v13, v12
    s_waitcnt lgkmcnt(0)
    v_readfirstlane_b32 s36, v13
    s_add_u32 s39, s39, 1
    s_cmp_eq_u32 s36, 4
    s_cbranch_scc1 L_kf_kernel_m9d
    s_sleep 1
    s_cmp_lt_u32 s39, 0x400000
    s_cbranch_scc1 L_kf_kernel_m9
L_kf_kernel_m9d:
    v_mov_b32 v14, 1511506921
    v_add_u32 v4, 40960, v4
    v_add_u32 v5, 40960, v5
    v_add_u32 v253, 40960, v252
    v_cmp_gt_u32 s[22:23], 24, v0
    s_sub_u32 s38, 15, s32
    s_mul_i32 s38, s38, 640
    s_lshr_b32 s38, s38, 10
    s_mov_b32 s39, 0
L_kf_kernel_gp:
    s_waitcnt vmcnt(0)
    v_cndmask_b32 v93, v14, v93, s[22:23]
    v_cndmask_b32 v95, v14, v95, s[22:23]
    v_and_b32 v12, v57, v59
    v_or_b32 v13, v57, v59
    v_and_b32 v15, v61, v63
    v_or3_b32 v13, v13, v61, v63
    v_and_b32 v12, v12, v15
    v_and_b32 v15, v65, v67
    v_or3_b32 v13, v13, v65, v67
    v_and_b32 v12, v12, v15
    v_and_b32 v15, v69, v71
    v_or3_b32 v13, v13, v69, v71
    v_and_b32 v12, v12, v15
    v_and_b32 v15, v73, v75
    v_or3_b32 v13, v13, v73, v75
    v_and_b32 v12, v12, v15
    v_and_b32 v15, v77, v79
    v_or3_b32 v13, v13, v77, v79
    v_and_b32 v12, v12, v15
    v_and_b32 v15, v81, v83
    v_or3_b32 v13, v13, v81, v83
    v_and_b32 v12, v12, v15
    v_and_b32 v15, v85, v87
    v_or3_b32 v13, v13, v85, v87
    v_and_b32 v12, v12, v15
    v_and_b32 v15, v89, v91
    v_or3_b32 v13, v13, v89, v91
    v_and_b32 v12, v12, v15
    v_and_b32 v15, v93, v95
    v_or3_b32 v13, v13, v93, v95
    v_and_b32 v12, v12, v15
    v_cmp_eq_u32 vcc, v12, v14
    v_cmp_eq_u32 s[24:25], v13, v14
    s_nop 0
    s_and_b64 s[24:25], s[24:25], vcc
    s_add_u32 s39, s39, 1
    s_cmp_eq_u64 s[24:25], -1
    s_cbranch_scc1 L_kf_kernel_gpv
    s_cmp_ge_u32 s39, 0x40000
    s_cbranch_scc1 L_kf_kernel_gpv
    s_cmp_gt_u32 s38, 0
    s_cbranch_scc1 L_kf_kernel_gs0
    buffer_load_dwordx4 v[56:59], v252, s[48:51], s70 offen offset:0 sc1
L_kf_kernel_gs0:
    s_cmp_gt_u32 s38, 1
    s_cbranch_scc1 L_kf_kernel_gs1
    buffer_load_dwordx4 v[60:63], v252, s[48:51], s70 offen offset:1024 sc1
L_kf_kernel_gs1:
    s_cmp_gt_u32 s38, 2
    s_cbranch_scc1 L_kf_kernel_gs2
    buffer_load_dwordx4 v[64:67], v252, s[48:51], s70 offen offset:2048 sc1
L_kf_kernel_gs2:
    s_cmp_gt_u32 s38, 3
    s_cbranch_scc1 L_kf_kernel_gs3
    buffer_load_dwordx4 v[68:71], v252, s[48:51], s70 offen offset:3072 sc1
L_kf_kernel_gs3:
    s_cmp_gt_u32 s38, 4
    s_cbranch_scc1 L_kf_kernel_gs4
    buffer_load_dwordx4 v[72:75], v252, s[48:51], s71 offen offset:0 sc1
L_kf_kernel_gs4:
    s_cmp_gt_u32 s38, 5
    s_cbranch_scc1 L_kf_kernel_gs5
    buffer_load_dwordx4 v[76:79], v252, s[48:51], s71 offen offset:1024 sc1
L_kf_kernel_gs5:
    s_cmp_gt_u32 s38, 6
    s_cbranch_scc1 L_kf_kernel_gs6
    buffer_load_dwordx4 v[80:83], v252, s[48:51], s71 offen offset:2048 sc1
L_kf_kernel_gs6:
    s_cmp_gt_u32 s38, 7
    s_cbranch_scc1 L_kf_kernel_gs7
    buffer_load_dwordx4 v[84:87], v252, s[48:51], s71 offen offset:3072 sc1
L_kf_kernel_gs7:
    s_cmp_gt_u32 s38, 8
    s_cbranch_scc1 L_kf_kernel_gs8
    buffer_load_dwordx4 v[88:91], v252, s[48:51], s69 offen offset:0 sc1
L_kf_kernel_gs8:
    buffer_load_dwordx4 v[92:95], v252, s[48:51], s69 offen offset:1024 sc1
    s_branch L_kf_kernel_gp
L_kf_kernel_gpv:
    ds_write_b128 v253, v[56:59] offset:0
    ds_write_b128 v253, v[60:63] offset:1024
    ds_write_b128 v253, v[64:67] offset:2048
    ds_write_b128 v253, v[68:71] offset:3072
    ds_write_b128 v253, v[72:75] offset:4096
    ds_write_b128 v253, v[76:79] offset:5120
    ds_write_b128 v253, v[80:83] offset:6144
    ds_write_b128 v253, v[84:87] offset:7168
    ds_write_b128 v253, v[88:91] offset:8192
    ds_write_b128 v253, v[92:95] offset:9216
    ds_read_b32 v220, v4 offset:0
    ds_read_b32 v235, v5 offset:512
    ds_read_b32 v219, v4 offset:640
    ds_read_b32 v234, v5 offset:1152
    ds_read_b32 v218, v4 offset:1280
    ds_read_b32 v233, v5 offset:1792
    ds_read_b32 v217, v4 offset:1920
    ds_read_b32 v232, v5 offset:2432
    ds_read_b32 v216, v4 offset:2560
    ds_read_b32 v231, v5 offset:3072
    ds_read_b32 v215, v4 offset:3200
    ds_read_b32 v230, v5 offset:3712
    ds_read_b32 v214, v4 offset:3840
    ds_read_b32 v229, v5 offset:4352
    ds_read_b32 v213, v4 offset:4480
    ds_read_b32 v228, v5 offset:4992
    ds_read_b32 v212, v4 offset:5120
    ds_read_b32 v227, v5 offset:5632
    ds_read_b32 v211, v4 offset:5760
    ds_read_b32 v226, v5 offset:6272
    ds_read_b32 v210, v4 offset:6400
    ds_read_b32 v225, v5 offset:6912
    ds_read_b32 v209, v4 offset:7040
    ds_read_b32 v224, v5 offset:7552
    ds_read_b32 v208, v4 offset:7680
    ds_read_b32 v223, v5 offset:8192
    ds_read_b32 v207, v4 offset:8320
    ds_read_b32 v222, v5 offset:8832
    ds_read_b32 v206, v4 offset:8960
    ds_read_b32 v221, v5 offset:9472
    s_waitcnt lgkmcnt(0)
L_kf_kernel_gpok:
    v_fmac_f32 v219, v202, v220
    v_fmac_f32 v234, v203, v235
    s_nop 0
    v_fmac_f32_dpp v219, v220, v204 row_ror:8 row_mask:0xf bank_mask:0xf
    v_fmac_f32_dpp v234, v235, v205 row_ror:8 row_mask:0xf bank_mask:0xf
    v_fmac_f32 v218, v202, v219
    v_fmac_f32 v233, v203, v234
    s_nop 0
    v_fmac_f32_dpp v218, v219, v204 row_ror:8 row_mask:0xf bank_mask:0xf
    v_fmac_f32_dpp v233, v234, v205 row_ror:8 row_mask:0xf bank_mask:0xf
    v_fmac_f32 v217, v202, v218
    v_fmac_f32 v232, v203, v233
    s_nop 0
    v_fmac_f32_dpp v217, v218, v204 row_ror:8 row_mask:0xf bank_mask:0xf
    v_fmac_f32_dpp v232, v233, v205 row_ror:8 row_mask:0xf bank_mask:0xf
    v_fmac_f32 v216, v202, v217
    v_fmac_f32 v231, v203, v232
    s_nop 0
    v_fmac_f32_dpp v216, v217, v204 row_ror:8 row_mask:0xf bank_mask:0xf
    v_fmac_f32_dpp v231, v232, v205 row_ror:8 row_mask:0xf bank_mask:0xf
    v_fmac_f32 v215, v202, v216
    v_fmac_f32 v230, v203, v231
    s_nop 0
    v_fmac_f32_dpp v215, v216, v204 row_ror:8 row_mask:0xf bank_mask:0xf
    v_fmac_f32_dpp v230, v231, v205 row_ror:8 row_mask:0xf bank_mask:0xf
    v_fmac_f32 v214, v202, v215
    v_fmac_f32 v229, v203, v230
    s_nop 0
    v_fmac_f32_dpp v214, v215, v204 row_ror:8 row_mask:0xf bank_mask:0xf
    v_fmac_f32_dpp v229, v230, v205 row_ror:8 row_mask:0xf bank_mask:0xf
    v_fmac_f32 v213, v202, v214
    v_fmac_f32 v228, v203, v229
    s_nop 0
    v_fmac_f32_dpp v213, v214, v204 row_ror:8 row_mask:0xf bank_mask:0xf
    v_fmac_f32_dpp v228, v229, v205 row_ror:8 row_mask:0xf bank_mask:0xf
    v_fmac_f32 v212, v202, v213
    v_fmac_f32 v227, v203, v228
    s_nop 0
    v_fmac_f32_dpp v212, v213, v204 row_ror:8 row_mask:0xf bank_mask:0xf
    v_fmac_f32_dpp v227, v228, v205 row_ror:8 row_mask:0xf bank_mask:0xf
    v_fmac_f32 v211, v202, v212
    v_fmac_f32 v226, v203, v227
    s_nop 0
    v_fmac_f32_dpp v211, v212, v204 row_ror:8 row_mask:0xf bank_mask:0xf
    v_fmac_f32_dpp v226, v227, v205 row_ror:8 row_mask:0xf bank_mask:0xf
    v_fmac_f32 v210, v202, v211
    v_fmac_f32 v225, v203, v226
    s_nop 0
    v_fmac_f32_dpp v210, v211, v204 row_ror:8 row_mask:0xf bank_mask:0xf
    v_fmac_f32_dpp v225, v226, v205 row_ror:8 row_mask:0xf bank_mask:0xf
    v_fmac_f32 v209, v202, v210
    v_fmac_f32 v224, v203, v225
    s_nop 0
    v_fmac_f32_dpp v209, v210, v204 row_ror:8 row_mask:0xf bank_mask:0xf
    v_fmac_f32_dpp v224, v225, v205 row_ror:8 row_mask:0xf bank_mask:0xf
    v_fmac_f32 v208, v202, v209
    v_fmac_f32 v223, v203, v224
    s_nop 0
    v_fmac_f32_dpp v208, v209, v204 row_ror:8 row_mask:0xf bank_mask:0xf
    v_fmac_f32_dpp v223, v224, v205 row_ror:8 row_mask:0xf bank_mask:0xf
    v_fmac_f32 v207, v202, v208
    v_fmac_f32 v222, v203, v223
    s_nop 0
    v_fmac_f32_dpp v207, v208, v204 row_ror:8 row_mask:0xf bank_mask:0xf
    v_fmac_f32_dpp v222, v223, v205 row_ror:8 row_mask:0xf bank_mask:0xf
    v_fmac_f32 v206, v202, v207
    v_fmac_f32 v221, v203, v222
    s_nop 0
    v_fmac_f32_dpp v206, v207, v204 row_ror:8 row_mask:0xf bank_mask:0xf
    v_fmac_f32_dpp v221, v222, v205 row_ror:8 row_mask:0xf bank_mask:0xf
    s_branch L_kf_kernel_hp
L_kf_kernel_r0:
    v_mov_b32 v206, 0
    v_mov_b32 v221, 0
L_kf_kernel_hp:
    ds_write_b32 v9, v206
    ds_write_b32 v11, v221 offset:256
    v_mov_b32 v12, 161164
    v_mov_b32 v13, 1
    s_mov_b64 exec, 1
    ds_add_u32 v12, v13
    s_mov_b64 exec, -1
L_kf_kernel_hw:
    v_mov_b32 v12, 161164
    s_mov_b32 s39, 0
L_kf_kernel_hwl:
    ds_read_b32 v13, v12
    s_waitcnt lgkmcnt(0)
    v_readfirstlane_b32 s36, v13
    s_add_u32 s39, s39, 1
    s_cmp_eq_u32 s36, 1
    s_cbranch_scc1 L_kf_kernel_hwld
    s_sleep 1
    s_cmp_lt_u32 s39, 0x400000
    s_cbranch_scc1 L_kf_kernel_hwl
L_kf_kernel_hwld:
    ds_read_b32 v88, v11 offset:0
    ds_read_b32 v89, v11 offset:64
    ds_read_b32 v90, v11 offset:128
    ds_read_b32 v91, v11 offset:192
    ds_read_b32 v92, v11 offset:256
    v_mul_u32_u24 v9, 272, v2
    v_lshlrev_b32 v12, 4, v1
    s_lshl_b32 s36, s35, 6
    v_add3_u32 v9, v9, v12, s36
    s_waitcnt lgkmcnt(0)
    v_fmac_f32 v152, v188, v88
    v_fmac_f32 v153, v189, v89
    v_fmac_f32 v154, v190, v90
    v_fmac_f32 v155, v191, v91
    v_fmac_f32 v156, v192, v92
    v_fmac_f32_dpp v152, v88, v193 row_ror:8 row_mask:0xf bank_mask:0xf
    v_fmac_f32_dpp v153, v89, v194 row_ror:8 row_mask:0xf bank_mask:0xf
    v_fmac_f32_dpp v154, v90, v195 row_ror:8 row_mask:0xf bank_mask:0xf
    v_fmac_f32_dpp v155, v91, v196 row_ror:8 row_mask:0xf bank_mask:0xf
    v_fmac_f32_dpp v156, v92, v197 row_ror:8 row_mask:0xf bank_mask:0xf
    v_fmac_f32 v16, v168, v152
    v_fmac_f32 v24, v169, v153
    v_fmac_f32 v32, v170, v154
    v_fmac_f32 v40, v171, v155
    v_fmac_f32 v48, v172, v156
    v_fmac_f32_dpp v16, v152, v173 row_ror:8 row_mask:0xf bank_mask:0xf
    v_fmac_f32_dpp v24, v153, v174 row_ror:8 row_mask:0xf bank_mask:0xf
    v_fmac_f32_dpp v32, v154, v175 row_ror:8 row_mask:0xf bank_mask:0xf
    v_fmac_f32_dpp v40, v155, v176 row_ror:8 row_mask:0xf bank_mask:0xf
    v_fmac_f32_dpp v48, v156, v177 row_ror:8 row_mask:0xf bank_mask:0xf
    v_fmac_f32 v17, v168, v16
    v_fmac_f32 v25, v169, v24
    v_fmac_f32 v33, v170, v32
    v_fmac_f32 v41, v171, v40
    v_fmac_f32 v49, v172, v48
    v_fmac_f32_dpp v17, v16, v173 row_ror:8 row_mask:0xf bank_mask:0xf
    v_fmac_f32_dpp v25, v24, v174 row_ror:8 row_mask:0xf bank_mask:0xf
    v_fmac_f32_dpp v33, v32, v175 row_ror:8 row_mask:0xf bank_mask:0xf
    v_fmac_f32_dpp v41, v40, v176 row_ror:8 row_mask:0xf bank_mask:0xf
    v_fmac_f32_dpp v49, v48, v177 row_ror:8 row_mask:0xf bank_mask:0xf
    v_fmac_f32 v18, v168, v17
    v_fmac_f32 v26, v169, v25
    v_fmac_f32 v34, v170, v33
    v_fmac_f32 v42, v171, v41
    v_fmac_f32 v50, v172, v49
    v_fmac_f32_dpp v18, v17, v173 row_ror:8 row_mask:0xf bank_mask:0xf
    v_fmac_f32_dpp v26, v25, v174 row_ror:8 row_mask:0xf bank_mask:0xf
    v_fmac_f32_dpp v34, v33, v175 row_ror:8 row_mask:0xf bank_mask:0xf
    v_fmac_f32_dpp v42, v41, v176 row_ror:8 row_mask:0xf bank_mask:0xf
    v_fmac_f32_dpp v50, v49, v177 row_ror:8 row_mask:0xf bank_mask:0xf
    v_fmac_f32 v19, v168, v18
    v_fmac_f32 v27, v169, v26
    v_fmac_f32 v35, v170, v34
    v_fmac_f32 v43, v171, v42
    v_fmac_f32 v51, v172, v50
    v_fmac_f32_dpp v19, v18, v173 row_ror:8 row_mask:0xf bank_mask:0xf
    v_fmac_f32_dpp v27, v26, v174 row_ror:8 row_mask:0xf bank_mask:0xf
    v_fmac_f32_dpp v35, v34, v175 row_ror:8 row_mask:0xf bank_mask:0xf
    v_fmac_f32_dpp v43, v42, v176 row_ror:8 row_mask:0xf bank_mask:0xf
    v_fmac_f32_dpp v51, v50, v177 row_ror:8 row_mask:0xf bank_mask:0xf
    v_fmac_f32 v20, v168, v19
    v_fmac_f32 v28, v169, v27
    v_fmac_f32 v36, v170, v35
    v_fmac_f32 v44, v171, v43
    v_fmac_f32 v52, v172, v51
    v_fmac_f32_dpp v20, v19, v173 row_ror:8 row_mask:0xf bank_mask:0xf
    v_fmac_f32_dpp v28, v27, v174 row_ror:8 row_mask:0xf bank_mask:0xf
    v_fmac_f32_dpp v36, v35, v175 row_ror:8 row_mask:0xf bank_mask:0xf
    v_fmac_f32_dpp v44, v43, v176 row_ror:8 row_mask:0xf bank_mask:0xf
    v_fmac_f32_dpp v52, v51, v177 row_ror:8 row_mask:0xf bank_mask:0xf
    v_fmac_f32 v21, v168, v20
    v_fmac_f32 v29, v169, v28
    v_fmac_f32 v37, v170, v36
    v_fmac_f32 v45, v171, v44
    v_fmac_f32 v53, v172, v52
    v_fmac_f32_dpp v21, v20, v173 row_ror:8 row_mask:0xf bank_mask:0xf
    v_fmac_f32_dpp v29, v28, v174 row_ror:8 row_mask:0xf bank_mask:0xf
    v_fmac_f32_dpp v37, v36, v175 row_ror:8 row_mask:0xf bank_mask:0xf
    v_fmac_f32_dpp v45, v44, v176 row_ror:8 row_mask:0xf bank_mask:0xf
    v_fmac_f32_dpp v53, v52, v177 row_ror:8 row_mask:0xf bank_mask:0xf
    v_fmac_f32 v22, v168, v21
    v_fmac_f32 v30, v169, v29
    v_fmac_f32 v38, v170, v37
    v_fmac_f32 v46, v171, v45
    v_fmac_f32 v54, v172, v53
    v_fmac_f32_dpp v22, v21, v173 row_ror:8 row_mask:0xf bank_mask:0xf
    v_fmac_f32_dpp v30, v29, v174 row_ror:8 row_mask:0xf bank_mask:0xf
    v_fmac_f32_dpp v38, v37, v175 row_ror:8 row_mask:0xf bank_mask:0xf
    v_fmac_f32_dpp v46, v45, v176 row_ror:8 row_mask:0xf bank_mask:0xf
    v_fmac_f32_dpp v54, v53, v177 row_ror:8 row_mask:0xf bank_mask:0xf
    v_fmac_f32 v23, v168, v22
    v_fmac_f32 v31, v169, v30
    v_fmac_f32 v39, v170, v38
    v_fmac_f32 v47, v171, v46
    v_fmac_f32 v55, v172, v54
    v_fmac_f32_dpp v23, v22, v173 row_ror:8 row_mask:0xf bank_mask:0xf
    v_fmac_f32_dpp v31, v30, v174 row_ror:8 row_mask:0xf bank_mask:0xf
    v_fmac_f32_dpp v39, v38, v175 row_ror:8 row_mask:0xf bank_mask:0xf
    v_fmac_f32_dpp v47, v46, v176 row_ror:8 row_mask:0xf bank_mask:0xf
    v_fmac_f32_dpp v55, v54, v177 row_ror:8 row_mask:0xf bank_mask:0xf
    v_pk_mul_f32 v[96:97], v[16:17], v[178:179] op_sel:[0,0] op_sel_hi:[1,0]
    v_pk_mul_f32 v[98:99], v[18:19], v[178:179] op_sel:[0,0] op_sel_hi:[1,0]
    v_pk_mul_f32 v[100:101], v[20:21], v[178:179] op_sel:[0,0] op_sel_hi:[1,0]
    v_pk_mul_f32 v[102:103], v[22:23], v[178:179] op_sel:[0,0] op_sel_hi:[1,0]
    v_fmac_f32_dpp v96, v16, v183 row_ror:8 row_mask:0xf bank_mask:0xf
    v_fmac_f32_dpp v97, v17, v183 row_ror:8 row_mask:0xf bank_mask:0xf
    v_fmac_f32_dpp v98, v18, v183 row_ror:8 row_mask:0xf bank_mask:0xf
    v_fmac_f32_dpp v99, v19, v183 row_ror:8 row_mask:0xf bank_mask:0xf
    v_fmac_f32_dpp v100, v20, v183 row_ror:8 row_mask:0xf bank_mask:0xf
    v_fmac_f32_dpp v101, v21, v183 row_ror:8 row_mask:0xf bank_mask:0xf
    v_fmac_f32_dpp v102, v22, v183 row_ror:8 row_mask:0xf bank_mask:0xf
    v_fmac_f32_dpp v103, v23, v183 row_ror:8 row_mask:0xf bank_mask:0xf
    v_cvt_pk_bf16_f32 v136, v96, v97
    v_cvt_pk_bf16_f32 v137, v98, v99
    v_cvt_pk_bf16_f32 v138, v100, v101
    v_cvt_pk_bf16_f32 v139, v102, v103
    ds_write_b128 v9, v[136:139] offset:0
    v_pk_mul_f32 v[104:105], v[24:25], v[178:179] op_sel:[0,1] op_sel_hi:[1,1]
    v_pk_mul_f32 v[106:107], v[26:27], v[178:179] op_sel:[0,1] op_sel_hi:[1,1]
    v_pk_mul_f32 v[108:109], v[28:29], v[178:179] op_sel:[0,1] op_sel_hi:[1,1]
    v_pk_mul_f32 v[110:111], v[30:31], v[178:179] op_sel:[0,1] op_sel_hi:[1,1]
    v_fmac_f32_dpp v104, v24, v184 row_ror:8 row_mask:0xf bank_mask:0xf
    v_fmac_f32_dpp v105, v25, v184 row_ror:8 row_mask:0xf bank_mask:0xf
    v_fmac_f32_dpp v106, v26, v184 row_ror:8 row_mask:0xf bank_mask:0xf
    v_fmac_f32_dpp v107, v27, v184 row_ror:8 row_mask:0xf bank_mask:0xf
    v_fmac_f32_dpp v108, v28, v184 row_ror:8 row_mask:0xf bank_mask:0xf
    v_fmac_f32_dpp v109, v29, v184 row_ror:8 row_mask:0xf bank_mask:0xf
    v_fmac_f32_dpp v110, v30, v184 row_ror:8 row_mask:0xf bank_mask:0xf
    v_fmac_f32_dpp v111, v31, v184 row_ror:8 row_mask:0xf bank_mask:0xf
    v_cvt_pk_bf16_f32 v140, v104, v105
    v_cvt_pk_bf16_f32 v141, v106, v107
    v_cvt_pk_bf16_f32 v142, v108, v109
    v_cvt_pk_bf16_f32 v143, v110, v111
    ds_write_b128 v9, v[140:143] offset:4352
    v_pk_mul_f32 v[112:113], v[32:33], v[180:181] op_sel:[0,0] op_sel_hi:[1,0]
    v_pk_mul_f32 v[114:115], v[34:35], v[180:181] op_sel:[0,0] op_sel_hi:[1,0]
    v_pk_mul_f32 v[116:117], v[36:37], v[180:181] op_sel:[0,0] op_sel_hi:[1,0]
    v_pk_mul_f32 v[118:119], v[38:39], v[180:181] op_sel:[0,0] op_sel_hi:[1,0]
    v_fmac_f32_dpp v112, v32, v185 row_ror:8 row_mask:0xf bank_mask:0xf
    v_fmac_f32_dpp v113, v33, v185 row_ror:8 row_mask:0xf bank_mask:0xf
    v_fmac_f32_dpp v114, v34, v185 row_ror:8 row_mask:0xf bank_mask:0xf
    v_fmac_f32_dpp v115, v35, v185 row_ror:8 row_mask:0xf bank_mask:0xf
    v_fmac_f32_dpp v116, v36, v185 row_ror:8 row_mask:0xf bank_mask:0xf
    v_fmac_f32_dpp v117, v37, v185 row_ror:8 row_mask:0xf bank_mask:0xf
    v_fmac_f32_dpp v118, v38, v185 row_ror:8 row_mask:0xf bank_mask:0xf
    v_fmac_f32_dpp v119, v39, v185 row_ror:8 row_mask:0xf bank_mask:0xf
    v_cvt_pk_bf16_f32 v144, v112, v113
    v_cvt_pk_bf16_f32 v145, v114, v115
    v_cvt_pk_bf16_f32 v146, v116, v117
    v_cvt_pk_bf16_f32 v147, v118, v119
    ds_write_b128 v9, v[144:147] offset:8704
    v_pk_mul_f32 v[120:121], v[40:41], v[180:181] op_sel:[0,1] op_sel_hi:[1,1]
    v_pk_mul_f32 v[122:123], v[42:43], v[180:181] op_sel:[0,1] op_sel_hi:[1,1]
    v_pk_mul_f32 v[124:125], v[44:45], v[180:181] op_sel:[0,1] op_sel_hi:[1,1]
    v_pk_mul_f32 v[126:127], v[46:47], v[180:181] op_sel:[0,1] op_sel_hi:[1,1]
    v_fmac_f32_dpp v120, v40, v186 row_ror:8 row_mask:0xf bank_mask:0xf
    v_fmac_f32_dpp v121, v41, v186 row_ror:8 row_mask:0xf bank_mask:0xf
    v_fmac_f32_dpp v122, v42, v186 row_ror:8 row_mask:0xf bank_mask:0xf
    v_fmac_f32_dpp v123, v43, v186 row_ror:8 row_mask:0xf bank_mask:0xf
    v_fmac_f32_dpp v124, v44, v186 row_ror:8 row_mask:0xf bank_mask:0xf
    v_fmac_f32_dpp v125, v45, v186 row_ror:8 row_mask:0xf bank_mask:0xf
    v_fmac_f32_dpp v126, v46, v186 row_ror:8 row_mask:0xf bank_mask:0xf
    v_fmac_f32_dpp v127, v47, v186 row_ror:8 row_mask:0xf bank_mask:0xf
    v_cvt_pk_bf16_f32 v148, v120, v121
    v_cvt_pk_bf16_f32 v149, v122, v123
    v_cvt_pk_bf16_f32 v150, v124, v125
    v_cvt_pk_bf16_f32 v151, v126, v127
    ds_write_b128 v9, v[148:151] offset:13056
    v_pk_mul_f32 v[128:129], v[48:49], v[182:183] op_sel:[0,0] op_sel_hi:[1,0]
    v_pk_mul_f32 v[130:131], v[50:51], v[182:183] op_sel:[0,0] op_sel_hi:[1,0]
    v_pk_mul_f32 v[132:133], v[52:53], v[182:183] op_sel:[0,0] op_sel_hi:[1,0]
    v_pk_mul_f32 v[134:135], v[54:55], v[182:183] op_sel:[0,0] op_sel_hi:[1,0]
    v_fmac_f32_dpp v128, v48, v187 row_ror:8 row_mask:0xf bank_mask:0xf
    v_fmac_f32_dpp v129, v49, v187 row_ror:8 row_mask:0xf bank_mask:0xf
    v_fmac_f32_dpp v130, v50, v187 row_ror:8 row_mask:0xf bank_mask:0xf
    v_fmac_f32_dpp v131, v51, v187 row_ror:8 row_mask:0xf bank_mask:0xf
    v_fmac_f32_dpp v132, v52, v187 row_ror:8 row_mask:0xf bank_mask:0xf
    v_fmac_f32_dpp v133, v53, v187 row_ror:8 row_mask:0xf bank_mask:0xf
    v_fmac_f32_dpp v134, v54, v187 row_ror:8 row_mask:0xf bank_mask:0xf
    v_fmac_f32_dpp v135, v55, v187 row_ror:8 row_mask:0xf bank_mask:0xf
    v_cvt_pk_bf16_f32 v152, v128, v129
    v_cvt_pk_bf16_f32 v153, v130, v131
    v_cvt_pk_bf16_f32 v154, v132, v133
    v_cvt_pk_bf16_f32 v155, v134, v135
    ds_write_b128 v9, v[152:155] offset:17408
    v_lshrrev_b32 v11, 2, v2
    v_mul_u32_u24 v11, 272, v11
    v_and_b32 v4, 3, v2
    v_lshlrev_b32 v4, 4, v4
    v_add3_u32 v11, v11, v4, s36
    v_mul_u32_u24 v4, 2176, v1
    v_add_u32 v4, v11, v4
    v_and_b32 v5, 1, v1
    v_mul_u32_u24 v5, 2176, v5
    v_lshrrev_b32 v7, 1, v1
    v_lshlrev_b32 v7, 3, v7
    v_add3_u32 v5, v11, v5, v7
    s_lshl_b32 s36, s32, 2
    s_add_u32 s36, s36, s35
    s_mul_i32 s36, s36, 81920
    s_mul_i32 s37, s33, 2560
    s_add_u32 s36, s36, s37
    s_add_u32 s36, s36, 6291456
    s_add_u32 s40, s30, s36
    s_addc_u32 s41, s31, 0
    s_and_b32 s41, s41, 0xffff
    s_mov_b32 s42, 43520
    s_mov_b32 s43, 0x00020000
    v_lshlrev_b32 v7, 4, v0
    v_and_b32 v10, 1, v1
    v_lshlrev_b32 v10, 8, v10
    v_lshlrev_b32 v8, 4, v2
    v_add_u32 v10, v10, v8
    v_lshrrev_b32 v8, 1, v1
    v_mul_u32_u24 v8, 40960, v8
    v_add_u32 v10, v10, v8
    s_mov_b32 s37, 40960
    s_waitcnt lgkmcnt(0)
    ds_read_b64_tr_b16 v[56:57], v4 offset:0
    ds_read_b64_tr_b16 v[58:59], v4 offset:1088
    ds_read_b64_tr_b16 v[60:61], v4 offset:8704
    ds_read_b64_tr_b16 v[62:63], v4 offset:9792
    ds_read_b64_tr_b16 v[64:65], v4 offset:8
    ds_read_b64_tr_b16 v[66:67], v4 offset:1096
    ds_read_b64_tr_b16 v[68:69], v4 offset:8712
    ds_read_b64_tr_b16 v[70:71], v4 offset:9800
    ds_read_b64_tr_b16 v[72:73], v5 offset:17408
    ds_read_b64_tr_b16 v[74:75], v5 offset:18496
    s_waitcnt lgkmcnt(8)
    buffer_store_dwordx4 v[56:59], v7, s[40:43], 0 offen offset:0 sc1
    s_waitcnt lgkmcnt(6)
    buffer_store_dwordx4 v[60:63], v7, s[40:43], 0 offen offset:1024 sc1
    s_waitcnt lgkmcnt(4)
    buffer_store_dwordx4 v[64:67], v7, s[40:43], s37 offen offset:0 sc1
    s_waitcnt lgkmcnt(2)
    buffer_store_dwordx4 v[68:71], v7, s[40:43], s37 offen offset:1024 sc1
    s_waitcnt lgkmcnt(0)
    buffer_store_dwordx4 v[72:75], v10, s[40:43], 0 offen offset:2048 sc1
    s_load_dwordx2 s[4:5], s[0:1], 0
    s_load_dwordx2 s[6:7], s[0:1], 64
    s_load_dwordx4 s[8:11], s[0:1], 104
    s_load_dwordx2 s[24:25], s[0:1], 96
    s_waitcnt vmcnt(0) lgkmcnt(0)
    v_mov_b32 v15, v254
    v_mov_b32 v4, 161196
    v_mov_b32 v5, 1
    s_mov_b64 exec, 1
    ds_add_u32 v4, v5
    s_mov_b64 exec, -1
    v_mov_b32 v4, 161188
    v_mov_b32 v5, 1
    s_mov_b64 exec, 1
    ds_add_u32 v4, v5
    s_mov_b64 exec, -1
    s_add_u32 s52, s30, 15515648
    s_addc_u32 s53, s31, 0
    s_and_b32 s53, s53, 0xffff
    s_mov_b32 s54, 8192
    s_mov_b32 s55, 0x00020000
    s_cmp_lg_u32 s35, 0
    s_cbranch_scc1 L_kf_kernel_Ynf
    v_mov_b32 v4, 161196
    s_mov_b32 s39, 0
L_kf_kernel_Yw0:
    ds_read_b32 v5, v4
    s_waitcnt lgkmcnt(0)
    v_readfirstlane_b32 s36, v5
    s_add_u32 s39, s39, 1
    s_cmp_eq_u32 s36, 4
    s_cbranch_scc1 L_kf_kernel_Yw0d
    s_sleep 1
    s_cmp_lt_u32 s39, 0x400000
    s_cbranch_scc1 L_kf_kernel_Yw0
L_kf_kernel_Yw0d:
    s_lshl_b32 s36, s32, 7
    s_lshl_b32 s39, s33, 2
    s_add_u32 s36, s36, s39
    s_add_u32 s36, s36, 2048
    v_mov_b32 v4, s36
    v_mov_b32 v5, 1511506921
    s_mov_b64 exec, 1
    buffer_store_dword v5, v4, s[52:55], 0 offen sc1
    s_mov_b64 exec, -1
L_kf_kernel_Ynf:
    s_and_b32 s36, s2, 7
    s_lshr_b32 s37, s2, 3
    s_and_b32 s60, s36, 3
    s_lshl_b32 s60, s60, 3
    s_and_b32 s38, s37, 7
    s_add_u32 s60, s60, s38
    s_lshr_b32 s61, s36, 2
    s_lshl_b32 s61, s61, 2
    s_lshr_b32 s38, s37, 3
    s_add_u32 s61, s61, s38
    v_lshlrev_b32 v2, 4, v0
    v_lshrrev_b32 v1, 4, v0
    v_and_b32 v3, 15, v0
    s_add_u32 s36, s35, 0
    s_and_b32 s36, s36, 3
    s_mul_i32 s36, s36, 40960
    v_add_u32 v240, s36, v2
    s_add_u32 s36, s35, 1
    s_and_b32 s36, s36, 3
    s_mul_i32 s36, s36, 40960
    v_add_u32 v241, s36, v2
    s_add_u32 s36, s35, 2
    s_and_b32 s36, s36, 3
    s_mul_i32 s36, s36, 40960
    v_add_u32 v242, s36, v2
    s_add_u32 s36, s35, 3
    s_and_b32 s36, s36, 3
    s_mul_i32 s36, s36, 40960
    v_add_u32 v243, s36, v2
    v_add_u32 v244, 0, v2
    v_add_u32 v245, 40960, v2
    v_add_u32 v246, 81920, v2
    v_add_u32 v247, 122880, v2
    v_add_u32 v248, 163840, v2
    s_mul_i32 s36, s60, 163840
    s_add_u32 s36, s36, 6291456
    s_add_u32 s40, s30, s36
    s_addc_u32 s41, s31, 0
    s_and_b32 s41, s41, 0xffff
    s_mov_b32 s42, 163840
    s_mov_b32 s43, 0x00020000
    s_mul_i32 s36, s61, 204800
    s_add_u32 s36, s36, 13500416
    s_add_u32 s44, s30, s36
    s_addc_u32 s45, s31, 0
    s_and_b32 s45, s45, 0xffff
    s_mov_b32 s46, 204800
    s_mov_b32 s47, 0x00020000
    s_mul_i32 s63, s35, 10240
    s_lshl_b32 s36, s60, 6
    s_lshr_b32 s37, s35, 1
    s_lshl_b32 s37, s37, 5
    s_add_u32 s36, s36, s37
    s_and_b32 s37, s35, 1
    s_lshl_b32 s37, s37, 2
    s_add_u32 s65, s36, s37
    s_mul_i32 s66, s61, 160
    s_waitcnt lgkmcnt(0)
    s_cmp_lg_u32 s35, 0
    s_cbranch_scc1 L_kf_kernel_Ypw
    s_mul_i32 s36, s33, 22528
    s_add_u32 s36, s36, 15155200
    s_add_u32 s56, s30, s36
    s_addc_u32 s57, s31, 0
    s_and_b32 s57, s57, 0xffff
    s_mov_b32 s58, 22528
    s_mov_b32 s59, 0x00020000
    s_lshl_b32 s36, s32, 7
    s_add_u32 s36, s36, 20480
    v_mov_b32 v4, s36
    s_mov_b32 s39, 0
L_kf_kernel_Ygo:
    v_readfirstlane_b32 s36, v15
    s_add_u32 s39, s39, 1
    s_cmp_eq_u32 s36, 1511506921
    s_cbranch_scc1 L_kf_kernel_Ygod
    buffer_load_dword v15, v4, s[56:59], 0 offen sc1
    s_waitcnt vmcnt(0)
    s_cmp_lt_u32 s39, 0x100000
    s_cbranch_scc1 L_kf_kernel_Ygo
L_kf_kernel_Ygod:
    v_mov_b32 v6, 1511506921
    s_lshr_b32 s36, s60, 1
    s_lshl_b32 s36, s36, 7
    s_add_u32 s36, s36, 2048
    v_lshlrev_b32 v4, 2, v3
    v_add_u32 v4, s36, v4
    s_lshl_b32 s36, s61, 7
    s_add_u32 s36, s36, 4096
    v_lshlrev_b32 v5, 2, v0
    v_add_u32 v5, s36, v5
    v_cmp_gt_u32 vcc, 32, v0
    s_nop 1
    v_cndmask_b32 v4, v4, v5, vcc
    s_mov_b32 s39, 0
L_kf_kernel_Yfl:
    buffer_load_dword v5, v4, s[52:55], 0 offen sc1
    s_waitcnt vmcnt(0)
    v_cmp_eq_u32 vcc, v5, v6
    s_add_u32 s39, s39, 1
    s_cmp_eq_u64 vcc, -1
    s_cbranch_scc1 L_kf_kernel_Yfld
    s_sleep 2
    s_cmp_lt_u32 s39, 0x100000
    s_cbranch_scc1 L_kf_kernel_Yfl
L_kf_kernel_Yfld:
    v_mov_b32 v4, 161236
    v_mov_b32 v5, 1
    s_mov_b64 exec, 1
    ds_add_u32 v4, v5
    s_mov_b64 exec, -1
L_kf_kernel_Ypw:
    v_mov_b32 v4, 161236
    s_mov_b32 s39, 0
L_kf_kernel_Ypwl:
    ds_read_b32 v5, v4
    s_waitcnt lgkmcnt(0)
    v_readfirstlane_b32 s36, v5
    s_add_u32 s39, s39, 1
    s_cmp_eq_u32 s36, 1
    s_cbranch_scc1 L_kf_kernel_Ypwld
    s_sleep 1
    s_cmp_lt_u32 s39, 0x400000
    s_cbranch_scc1 L_kf_kernel_Ypwl
L_kf_kernel_Ypwld:
    s_setprio 0
    buffer_load_dwordx4 v[96:99], v240, s[40:43], s63 offen offset:0 sc1
    buffer_load_dwordx4 v[100:103], v241, s[40:43], s63 offen offset:0 sc1
    buffer_load_dwordx4 v[104:107], v242, s[40:43], s63 offen offset:0 sc1
    buffer_load_dwordx4 v[108:111], v243, s[40:43], s63 offen offset:0 sc1
    buffer_load_dwordx4 v[112:115], v244, s[44:47], s63 offen offset:0 sc1
    buffer_load_dwordx4 v[116:119], v245, s[44:47], s63 offen offset:0 sc1
    buffer_load_dwordx4 v[120:123], v246, s[44:47], s63 offen offset:0 sc1
    buffer_load_dwordx4 v[124:127], v247, s[44:47], s63 offen offset:0 sc1
    buffer_load_dwordx4 v[128:131], v248, s[44:47], s63 offen offset:0 sc1
    buffer_load_dwordx4 v[132:135], v240, s[40:43], s63 offen offset:1024 sc1
    buffer_load_dwordx4 v[136:139], v241, s[40:43], s63 offen offset:1024 sc1
    buffer_load_dwordx4 v[140:143], v242, s[40:43], s63 offen offset:1024 sc1
    buffer_load_dwordx4 v[144:147], v243, s[40:43], s63 offen offset:1024 sc1
    buffer_load_dwordx4 v[148:151], v244, s[44:47], s63 offen offset:1024 sc1
    buffer_load_dwordx4 v[152:155], v245, s[44:47], s63 offen offset:1024 sc1
    buffer_load_dwordx4 v[156:159], v246, s[44:47], s63 offen offset:1024 sc1
    buffer_load_dwordx4 v[160:163], v247, s[44:47], s63 offen offset:1024 sc1
    buffer_load_dwordx4 v[164:167], v248, s[44:47], s63 offen offset:1024 sc1
    buffer_load_dwordx4 v[168:171], v240, s[40:43], s63 offen offset:2048 sc1
    buffer_load_dwordx4 v[172:175], v241, s[40:43], s63 offen offset:2048 sc1
    buffer_load_dwordx4 v[176:179], v242, s[40:43], s63 offen offset:2048 sc1
    buffer_load_dwordx4 v[180:183], v243, s[40:43], s63 offen offset:2048 sc1
    buffer_load_dwordx4 v[184:187], v244, s[44:47], s63 offen offset:2048 sc1
    buffer_load_dwordx4 v[188:191], v245, s[44:47], s63 offen offset:2048 sc1
    buffer_load_dwordx4 v[192:195], v246, s[44:47], s63 offen offset:2048 sc1
    buffer_load_dwordx4 v[196:199], v247, s[44:47], s63 offen offset:2048 sc1
    buffer_load_dwordx4 v[200:203], v248, s[44:47], s63 offen offset:2048 sc1
    s_mul_i32 s62, s35, 15360
    v_add_u32 v252, s62, v2
    s_waitcnt vmcnt(18)
    v_mfma_f32_16x16x32_bf16 v[16:19], v[112:115], v[96:99], 0
    buffer_load_dwordx4 v[204:207], v240, s[40:43], s63 offen offset:3072 sc1
    v_mfma_f32_16x16x32_bf16 v[20:23], v[116:119], v[96:99], 0
    v_mfma_f32_16x16x32_bf16 v[24:27], v[120:123], v[96:99], 0
    buffer_load_dwordx4 v[208:211], v241, s[40:43], s63 offen offset:3072 sc1
    v_mfma_f32_16x16x32_bf16 v[28:31], v[124:127], v[96:99], 0
    v_mfma_f32_16x16x32_bf16 v[32:35], v[128:131], v[96:99], 0
    buffer_load_dwordx4 v[212:215], v242, s[40:43], s63 offen offset:3072 sc1
    v_mfma_f32_16x16x32_bf16 v[36:39], v[112:115], v[100:103], 0
    v_mfma_f32_16x16x32_bf16 v[40:43], v[116:119], v[100:103], 0
    buffer_load_dwordx4 v[216:219], v243, s[40:43], s63 offen offset:3072 sc1
    v_mfma_f32_16x16x32_bf16 v[44:47], v[120:123], v[100:103], 0
    v_mfma_f32_16x16x32_bf16 v[48:51], v[124:127], v[100:103], 0
    buffer_load_dwordx4 v[220:223], v244, s[44:47], s63 offen offset:3072 sc1
    v_mfma_f32_16x16x32_bf16 v[52:55], v[128:131], v[100:103], 0
    v_mfma_f32_16x16x32_bf16 v[56:59], v[112:115], v[104:107], 0
    buffer_load_dwordx4 v[224:227], v245, s[44:47], s63 offen offset:3072 sc1
    v_mfma_f32_16x16x32_bf16 v[60:63], v[116:119], v[104:107], 0
    v_mfma_f32_16x16x32_bf16 v[64:67], v[120:123], v[104:107], 0
    buffer_load_dwordx4 v[228:231], v246, s[44:47], s63 offen offset:3072 sc1
    v_mfma_f32_16x16x32_bf16 v[68:71], v[124:127], v[104:107], 0
    v_mfma_f32_16x16x32_bf16 v[72:75], v[128:131], v[104:107], 0
    buffer_load_dwordx4 v[232:235], v247, s[44:47], s63 offen offset:3072 sc1
    v_mfma_f32_16x16x32_bf16 v[76:79], v[112:115], v[108:111], 0
    v_mfma_f32_16x16x32_bf16 v[80:83], v[116:119], v[108:111], 0
    buffer_load_dwordx4 v[236:239], v248, s[44:47], s63 offen offset:3072 sc1
    s_add_u32 s63, s63, 4096
    v_mfma_f32_16x16x32_bf16 v[84:87], v[120:123], v[108:111], 0
    v_mfma_f32_16x16x32_bf16 v[88:91], v[124:127], v[108:111], 0
    v_mfma_f32_16x16x32_bf16 v[92:95], v[128:131], v[108:111], 0
    s_waitcnt vmcnt(18)
    v_mfma_f32_16x16x32_bf16 v[16:19], v[148:151], v[132:135], v[16:19]
    buffer_load_dwordx4 v[96:99], v240, s[40:43], s63 offen offset:0 sc1
    v_mfma_f32_16x16x32_bf16 v[20:23], v[152:155], v[132:135], v[20:23]
    v_mfma_f32_16x16x32_bf16 v[24:27], v[156:159], v[132:135], v[24:27]
    buffer_load_dwordx4 v[100:103], v241, s[40:43], s63 offen offset:0 sc1
    v_mfma_f32_16x16x32_bf16 v[28:31], v[160:163], v[132:135], v[28:31]
    v_mfma_f32_16x16x32_bf16 v[32:35], v[164:167], v[132:135], v[32:35]
    buffer_load_dwordx4 v[104:107], v242, s[40:43], s63 offen offset:0 sc1
    v_mfma_f32_16x16x32_bf16 v[36:39], v[148:151], v[136:139], v[36:39]
    v_mfma_f32_16x16x32_bf16 v[40:43], v[152:155], v[136:139], v[40:43]
    buffer_load_dwordx4 v[108:111], v243, s[40:43], s63 offen offset:0 sc1
    v_mfma_f32_16x16x32_bf16 v[44:47], v[156:159], v[136:139], v[44:47]
    v_mfma_f32_16x16x32_bf16 v[48:51], v[160:163], v[136:139], v[48:51]
    buffer_load_dwordx4 v[112:115], v244, s[44:47], s63 offen offset:0 sc1
    v_mfma_f32_16x16x32_bf16 v[52:55], v[164:167], v[136:139], v[52:55]
    v_mfma_f32_16x16x32_bf16 v[56:59], v[148:151], v[140:143], v[56:59]
    buffer_load_dwordx4 v[116:119], v245, s[44:47], s63 offen offset:0 sc1
    v_mfma_f32_16x16x32_bf16 v[60:63], v[152:155], v[140:143], v[60:63]
    v_mfma_f32_16x16x32_bf16 v[64:67], v[156:159], v[140:143], v[64:67]
    buffer_load_dwordx4 v[120:123], v246, s[44:47], s63 offen offset:0 sc1
    v_mfma_f32_16x16x32_bf16 v[68:71], v[160:163], v[140:143], v[68:71]
    v_mfma_f32_16x16x32_bf16 v[72:75], v[164:167], v[140:143], v[72:75]
    buffer_load_dwordx4 v[124:127], v247, s[44:47], s63 offen offset:0 sc1
    v_mfma_f32_16x16x32_bf16 v[76:79], v[148:151], v[144:147], v[76:79]
    v_mfma_f32_16x16x32_bf16 v[80:83], v[152:155], v[144:147], v[80:83]
    buffer_load_dwordx4 v[128:131], v248, s[44:47], s63 offen offset:0 sc1
    v_mfma_f32_16x16x32_bf16 v[84:87], v[156:159], v[144:147], v[84:87]
    v_mfma_f32_16x16x32_bf16 v[88:91], v[160:163], v[144:147], v[88:91]
    v_mfma_f32_16x16x32_bf16 v[92:95], v[164:167], v[144:147], v[92:95]
    s_waitcnt vmcnt(18)
    v_mfma_f32_16x16x32_bf16 v[16:19], v[184:187], v[168:171], v[16:19]
    buffer_load_dwordx4 v[132:135], v240, s[40:43], s63 offen offset:1024 sc1
    v_mfma_f32_16x16x32_bf16 v[20:23], v[188:191], v[168:171], v[20:23]
    v_mfma_f32_16x16x32_bf16 v[24:27], v[192:195], v[168:171], v[24:27]
    buffer_load_dwordx4 v[136:139], v241, s[40:43], s63 offen offset:1024 sc1
    v_mfma_f32_16x16x32_bf16 v[28:31], v[196:199], v[168:171], v[28:31]
    v_mfma_f32_16x16x32_bf16 v[32:35], v[200:203], v[168:171], v[32:35]
    buffer_load_dwordx4 v[140:143], v242, s[40:43], s63 offen offset:1024 sc1
    v_mfma_f32_16x16x32_bf16 v[36:39], v[184:187], v[172:175], v[36:39]
    v_mfma_f32_16x16x32_bf16 v[40:43], v[188:191], v[172:175], v[40:43]
    buffer_load_dwordx4 v[144:147], v243, s[40:43], s63 offen offset:1024 sc1
    v_mfma_f32_16x16x32_bf16 v[44:47], v[192:195], v[172:175], v[44:47]
    v_mfma_f32_16x16x32_bf16 v[48:51], v[196:199], v[172:175], v[48:51]
    buffer_load_dwordx4 v[148:151], v244, s[44:47], s63 offen offset:1024 sc1
    v_mfma_f32_16x16x32_bf16 v[52:55], v[200:203], v[172:175], v[52:55]
    v_mfma_f32_16x16x32_bf16 v[56:59], v[184:187], v[176:179], v[56:59]
    buffer_load_dwordx4 v[152:155], v245, s[44:47], s63 offen offset:1024 sc1
    v_mfma_f32_16x16x32_bf16 v[60:63], v[188:191], v[176:179], v[60:63]
    v_mfma_f32_16x16x32_bf16 v[64:67], v[192:195], v[176:179], v[64:67]
    buffer_load_dwordx4 v[156:159], v246, s[44:47], s63 offen offset:1024 sc1
    v_mfma_f32_16x16x32_bf16 v[68:71], v[196:199], v[176:179], v[68:71]
    v_mfma_f32_16x16x32_bf16 v[72:75], v[200:203], v[176:179], v[72:75]
    buffer_load_dwordx4 v[160:163], v247, s[44:47], s63 offen offset:1024 sc1
    v_mfma_f32_16x16x32_bf16 v[76:79], v[184:187], v[180:183], v[76:79]
    v_mfma_f32_16x16x32_bf16 v[80:83], v[188:191], v[180:183], v[80:83]
    buffer_load_dwordx4 v[164:167], v248, s[44:47], s63 offen offset:1024 sc1
    v_mfma_f32_16x16x32_bf16 v[84:87], v[192:195], v[180:183], v[84:87]
    v_mfma_f32_16x16x32_bf16 v[88:91], v[196:199], v[180:183], v[88:91]
    v_mfma_f32_16x16x32_bf16 v[92:95], v[200:203], v[180:183], v[92:95]
    s_waitcnt vmcnt(18)
    v_mfma_f32_16x16x32_bf16 v[16:19], v[220:223], v[204:207], v[16:19]
    buffer_load_dwordx4 v[168:171], v240, s[40:43], s63 offen offset:2048 sc1
    v_mfma_f32_16x16x32_bf16 v[20:23], v[224:227], v[204:207], v[20:23]
    v_mfma_f32_16x16x32_bf16 v[24:27], v[228:231], v[204:207], v[24:27]
    buffer_load_dwordx4 v[172:175], v241, s[40:43], s63 offen offset:2048 sc1
    v_mfma_f32_16x16x32_bf16 v[28:31], v[232:235], v[204:207], v[28:31]
    v_mfma_f32_16x16x32_bf16 v[32:35], v[236:239], v[204:207], v[32:35]
    buffer_load_dwordx4 v[176:179], v242, s[40:43], s63 offen offset:2048 sc1
    v_mfma_f32_16x16x32_bf16 v[36:39], v[220:223], v[208:211], v[36:39]
    v_mfma_f32_16x16x32_bf16 v[40:43], v[224:227], v[208:211], v[40:43]
    buffer_load_dwordx4 v[180:183], v243, s[40:43], s63 offen offset:2048 sc1
    v_mfma_f32_16x16x32_bf16 v[44:47], v[228:231], v[208:211], v[44:47]
    v_mfma_f32_16x16x32_bf16 v[48:51], v[232:235], v[208:211], v[48:51]
    buffer_load_dwordx4 v[184:187], v244, s[44:47], s63 offen offset:2048 sc1
    v_mfma_f32_16x16x32_bf16 v[52:55], v[236:239], v[208:211], v[52:55]
    v_mfma_f32_16x16x32_bf16 v[56:59], v[220:223], v[212:215], v[56:59]
    buffer_load_dwordx4 v[188:191], v245, s[44:47], s63 offen offset:2048 sc1
    v_mfma_f32_16x16x32_bf16 v[60:63], v[224:227], v[212:215], v[60:63]
    v_mfma_f32_16x16x32_bf16 v[64:67], v[228:231], v[212:215], v[64:67]
    buffer_load_dwordx4 v[192:195], v246, s[44:47], s63 offen offset:2048 sc1
    v_mfma_f32_16x16x32_bf16 v[68:71], v[232:235], v[212:215], v[68:71]
    v_mfma_f32_16x16x32_bf16 v[72:75], v[236:239], v[212:215], v[72:75]
    buffer_load_dwordx4 v[196:199], v247, s[44:47], s63 offen offset:2048 sc1
    v_mfma_f32_16x16x32_bf16 v[76:79], v[220:223], v[216:219], v[76:79]
    v_mfma_f32_16x16x32_bf16 v[80:83], v[224:227], v[216:219], v[80:83]
    buffer_load_dwordx4 v[200:203], v248, s[44:47], s63 offen offset:2048 sc1
    v_mfma_f32_16x16x32_bf16 v[84:87], v[228:231], v[216:219], v[84:87]
    v_mfma_f32_16x16x32_bf16 v[88:91], v[232:235], v[216:219], v[88:91]
    v_mfma_f32_16x16x32_bf16 v[92:95], v[236:239], v[216:219], v[92:95]
    s_waitcnt vmcnt(18)
    v_mfma_f32_16x16x32_bf16 v[16:19], v[112:115], v[96:99], v[16:19]
    buffer_load_dwordx4 v[204:207], v240, s[40:43], s63 offen offset:3072 sc1
    v_mfma_f32_16x16x32_bf16 v[20:23], v[116:119], v[96:99], v[20:23]
    v_mfma_f32_16x16x32_bf16 v[24:27], v[120:123], v[96:99], v[24:27]
    buffer_load_dwordx4 v[208:211], v241, s[40:43], s63 offen offset:3072 sc1
    v_mfma_f32_16x16x32_bf16 v[28:31], v[124:127], v[96:99], v[28:31]
    v_mfma_f32_16x16x32_bf16 v[32:35], v[128:131], v[96:99], v[32:35]
    buffer_load_dwordx4 v[212:215], v242, s[40:43], s63 offen offset:3072 sc1
    v_mfma_f32_16x16x32_bf16 v[36:39], v[112:115], v[100:103], v[36:39]
    v_mfma_f32_16x16x32_bf16 v[40:43], v[116:119], v[100:103], v[40:43]
    buffer_load_dwordx4 v[216:219], v243, s[40:43], s63 offen offset:3072 sc1
    v_mfma_f32_16x16x32_bf16 v[44:47], v[120:123], v[100:103], v[44:47]
    v_mfma_f32_16x16x32_bf16 v[48:51], v[124:127], v[100:103], v[48:51]
    buffer_load_dwordx4 v[220:223], v244, s[44:47], s63 offen offset:3072 sc1
    v_mfma_f32_16x16x32_bf16 v[52:55], v[128:131], v[100:103], v[52:55]
    v_mfma_f32_16x16x32_bf16 v[56:59], v[112:115], v[104:107], v[56:59]
    buffer_load_dwordx4 v[224:227], v245, s[44:47], s63 offen offset:3072 sc1
    v_mfma_f32_16x16x32_bf16 v[60:63], v[116:119], v[104:107], v[60:63]
    v_mfma_f32_16x16x32_bf16 v[64:67], v[120:123], v[104:107], v[64:67]
    buffer_load_dwordx4 v[228:231], v246, s[44:47], s63 offen offset:3072 sc1
    v_mfma_f32_16x16x32_bf16 v[68:71], v[124:127], v[104:107], v[68:71]
    v_mfma_f32_16x16x32_bf16 v[72:75], v[128:131], v[104:107], v[72:75]
    buffer_load_dwordx4 v[232:235], v247, s[44:47], s63 offen offset:3072 sc1
    v_mfma_f32_16x16x32_bf16 v[76:79], v[112:115], v[108:111], v[76:79]
    v_mfma_f32_16x16x32_bf16 v[80:83], v[116:119], v[108:111], v[80:83]
    buffer_load_dwordx4 v[236:239], v248, s[44:47], s63 offen offset:3072 sc1
    s_add_u32 s63, s63, 4096
    v_mfma_f32_16x16x32_bf16 v[84:87], v[120:123], v[108:111], v[84:87]
    v_mfma_f32_16x16x32_bf16 v[88:91], v[124:127], v[108:111], v[88:91]
    v_mfma_f32_16x16x32_bf16 v[92:95], v[128:131], v[108:111], v[92:95]
    s_waitcnt vmcnt(18)
    v_mfma_f32_16x16x32_bf16 v[16:19], v[148:151], v[132:135], v[16:19]
    buffer_load_dwordx4 v[96:99], v240, s[40:43], s63 offen offset:0 sc1
    v_mfma_f32_16x16x32_bf16 v[20:23], v[152:155], v[132:135], v[20:23]
    v_mfma_f32_16x16x32_bf16 v[24:27], v[156:159], v[132:135], v[24:27]
    buffer_load_dwordx4 v[100:103], v241, s[40:43], s63 offen offset:0 sc1
    v_mfma_f32_16x16x32_bf16 v[28:31], v[160:163], v[132:135], v[28:31]
    v_mfma_f32_16x16x32_bf16 v[32:35], v[164:167], v[132:135], v[32:35]
    buffer_load_dwordx4 v[104:107], v242, s[40:43], s63 offen offset:0 sc1
    v_mfma_f32_16x16x32_bf16 v[36:39], v[148:151], v[136:139], v[36:39]
    v_mfma_f32_16x16x32_bf16 v[40:43], v[152:155], v[136:139], v[40:43]
    buffer_load_dwordx4 v[108:111], v243, s[40:43], s63 offen offset:0 sc1
    v_mfma_f32_16x16x32_bf16 v[44:47], v[156:159], v[136:139], v[44:47]
    v_mfma_f32_16x16x32_bf16 v[48:51], v[160:163], v[136:139], v[48:51]
    buffer_load_dwordx4 v[112:115], v244, s[44:47], s63 offen offset:0 sc1
    v_mfma_f32_16x16x32_bf16 v[52:55], v[164:167], v[136:139], v[52:55]
    v_mfma_f32_16x16x32_bf16 v[56:59], v[148:151], v[140:143], v[56:59]
    buffer_load_dwordx4 v[116:119], v245, s[44:47], s63 offen offset:0 sc1
    v_mfma_f32_16x16x32_bf16 v[60:63], v[152:155], v[140:143], v[60:63]
    v_mfma_f32_16x16x32_bf16 v[64:67], v[156:159], v[140:143], v[64:67]
    buffer_load_dwordx4 v[120:123], v246, s[44:47], s63 offen offset:0 sc1
    v_mfma_f32_16x16x32_bf16 v[68:71], v[160:163], v[140:143], v[68:71]
    v_mfma_f32_16x16x32_bf16 v[72:75], v[164:167], v[140:143], v[72:75]
    buffer_load_dwordx4 v[124:127], v247, s[44:47], s63 offen offset:0 sc1
    v_mfma_f32_16x16x32_bf16 v[76:79], v[148:151], v[144:147], v[76:79]
    v_mfma_f32_16x16x32_bf16 v[80:83], v[152:155], v[144:147], v[80:83]
    buffer_load_dwordx4 v[128:131], v248, s[44:47], s63 offen offset:0 sc1
    v_mfma_f32_16x16x32_bf16 v[84:87], v[156:159], v[144:147], v[84:87]
    v_mfma_f32_16x16x32_bf16 v[88:91], v[160:163], v[144:147], v[88:91]
    v_mfma_f32_16x16x32_bf16 v[92:95], v[164:167], v[144:147], v[92:95]
    s_waitcnt vmcnt(18)
    v_mfma_f32_16x16x32_bf16 v[16:19], v[184:187], v[168:171], v[16:19]
    buffer_load_dwordx4 v[132:135], v240, s[40:43], s63 offen offset:1024 sc1
    v_mfma_f32_16x16x32_bf16 v[20:23], v[188:191], v[168:171], v[20:23]
    v_mfma_f32_16x16x32_bf16 v[24:27], v[192:195], v[168:171], v[24:27]
    buffer_load_dwordx4 v[136:139], v241, s[40:43], s63 offen offset:1024 sc1
    v_mfma_f32_16x16x32_bf16 v[28:31], v[196:199], v[168:171], v[28:31]
    v_mfma_f32_16x16x32_bf16 v[32:35], v[200:203], v[168:171], v[32:35]
    buffer_load_dwordx4 v[140:143], v242, s[40:43], s63 offen offset:1024 sc1
    v_mfma_f32_16x16x32_bf16 v[36:39], v[184:187], v[172:175], v[36:39]
    v_mfma_f32_16x16x32_bf16 v[40:43], v[188:191], v[172:175], v[40:43]
    buffer_load_dwordx4 v[144:147], v243, s[40:43], s63 offen offset:1024 sc1
    v_mfma_f32_16x16x32_bf16 v[44:47], v[192:195], v[172:175], v[44:47]
    v_mfma_f32_16x16x32_bf16 v[48:51], v[196:199], v[172:175], v[48:51]
    buffer_load_dwordx4 v[148:151], v244, s[44:47], s63 offen offset:1024 sc1
    v_mfma_f32_16x16x32_bf16 v[52:55], v[200:203], v[172:175], v[52:55]
    v_mfma_f32_16x16x32_bf16 v[56:59], v[184:187], v[176:179], v[56:59]
    buffer_load_dwordx4 v[152:155], v245, s[44:47], s63 offen offset:1024 sc1
    v_mfma_f32_16x16x32_bf16 v[60:63], v[188:191], v[176:179], v[60:63]
    v_mfma_f32_16x16x32_bf16 v[64:67], v[192:195], v[176:179], v[64:67]
    buffer_load_dwordx4 v[156:159], v246, s[44:47], s63 offen offset:1024 sc1
    v_mfma_f32_16x16x32_bf16 v[68:71], v[196:199], v[176:179], v[68:71]
    v_mfma_f32_16x16x32_bf16 v[72:75], v[200:203], v[176:179], v[72:75]
    buffer_load_dwordx4 v[160:163], v247, s[44:47], s63 offen offset:1024 sc1
    v_mfma_f32_16x16x32_bf16 v[76:79], v[184:187], v[180:183], v[76:79]
    v_mfma_f32_16x16x32_bf16 v[80:83], v[188:191], v[180:183], v[80:83]
    buffer_load_dwordx4 v[164:167], v248, s[44:47], s63 offen offset:1024 sc1
    v_mfma_f32_16x16x32_bf16 v[84:87], v[192:195], v[180:183], v[84:87]
    v_mfma_f32_16x16x32_bf16 v[88:91], v[196:199], v[180:183], v[88:91]
    v_mfma_f32_16x16x32_bf16 v[92:95], v[200:203], v[180:183], v[92:95]
    s_waitcnt vmcnt(18)
    v_mfma_f32_16x16x32_bf16 v[16:19], v[220:223], v[204:207], v[16:19]
    v_mfma_f32_16x16x32_bf16 v[20:23], v[224:227], v[204:207], v[20:23]
    v_mfma_f32_16x16x32_bf16 v[24:27], v[228:231], v[204:207], v[24:27]
    v_mfma_f32_16x16x32_bf16 v[28:31], v[232:235], v[204:207], v[28:31]
    v_mfma_f32_16x16x32_bf16 v[32:35], v[236:239], v[204:207], v[32:35]
    v_mfma_f32_16x16x32_bf16 v[36:39], v[220:223], v[208:211], v[36:39]
    v_mfma_f32_16x16x32_bf16 v[40:43], v[224:227], v[208:211], v[40:43]
    v_mfma_f32_16x16x32_bf16 v[44:47], v[228:231], v[208:211], v[44:47]
    v_mfma_f32_16x16x32_bf16 v[48:51], v[232:235], v[208:211], v[48:51]
    v_mfma_f32_16x16x32_bf16 v[52:55], v[236:239], v[208:211], v[52:55]
    v_mfma_f32_16x16x32_bf16 v[56:59], v[220:223], v[212:215], v[56:59]
    v_mfma_f32_16x16x32_bf16 v[60:63], v[224:227], v[212:215], v[60:63]
    v_mfma_f32_16x16x32_bf16 v[64:67], v[228:231], v[212:215], v[64:67]
    v_mfma_f32_16x16x32_bf16 v[68:71], v[232:235], v[212:215], v[68:71]
    v_mfma_f32_16x16x32_bf16 v[72:75], v[236:239], v[212:215], v[72:75]
    v_mfma_f32_16x16x32_bf16 v[76:79], v[220:223], v[216:219], v[76:79]
    v_mfma_f32_16x16x32_bf16 v[80:83], v[224:227], v[216:219], v[80:83]
    v_mfma_f32_16x16x32_bf16 v[84:87], v[228:231], v[216:219], v[84:87]
    v_mfma_f32_16x16x32_bf16 v[88:91], v[232:235], v[216:219], v[88:91]
    v_mfma_f32_16x16x32_bf16 v[92:95], v[236:239], v[216:219], v[92:95]
    s_waitcnt vmcnt(9)
    v_mfma_f32_16x16x32_bf16 v[16:19], v[112:115], v[96:99], v[16:19]
    v_mfma_f32_16x16x32_bf16 v[20:23], v[116:119], v[96:99], v[20:23]
    v_mfma_f32_16x16x32_bf16 v[24:27], v[120:123], v[96:99], v[24:27]
    v_mfma_f32_16x16x32_bf16 v[28:31], v[124:127], v[96:99], v[28:31]
    v_mfma_f32_16x16x32_bf16 v[32:35], v[128:131], v[96:99], v[32:35]
    v_mfma_f32_16x16x32_bf16 v[36:39], v[112:115], v[100:103], v[36:39]
    v_mfma_f32_16x16x32_bf16 v[40:43], v[116:119], v[100:103], v[40:43]
    v_mfma_f32_16x16x32_bf16 v[44:47], v[120:123], v[100:103], v[44:47]
    v_mfma_f32_16x16x32_bf16 v[48:51], v[124:127], v[100:103], v[48:51]
    v_mfma_f32_16x16x32_bf16 v[52:55], v[128:131], v[100:103], v[52:55]
    v_mfma_f32_16x16x32_bf16 v[56:59], v[112:115], v[104:107], v[56:59]
    v_mfma_f32_16x16x32_bf16 v[60:63], v[116:119], v[104:107], v[60:63]
    v_mfma_f32_16x16x32_bf16 v[64:67], v[120:123], v[104:107], v[64:67]
    v_mfma_f32_16x16x32_bf16 v[68:71], v[124:127], v[104:107], v[68:71]
    v_mfma_f32_16x16x32_bf16 v[72:75], v[128:131], v[104:107], v[72:75]
    v_mfma_f32_16x16x32_bf16 v[76:79], v[112:115], v[108:111], v[76:79]
    v_mfma_f32_16x16x32_bf16 v[80:83], v[116:119], v[108:111], v[80:83]
    v_mfma_f32_16x16x32_bf16 v[84:87], v[120:123], v[108:111], v[84:87]
    v_mfma_f32_16x16x32_bf16 v[88:91], v[124:127], v[108:111], v[88:91]
    v_mfma_f32_16x16x32_bf16 v[92:95], v[128:131], v[108:111], v[92:95]
    s_waitcnt vmcnt(0)
    v_mov_b32 v4, 161188
    s_mov_b32 s39, 0
L_kf_kernel_Yw1:
    ds_read_b32 v5, v4
    s_waitcnt lgkmcnt(0)
    v_readfirstlane_b32 s36, v5
    s_add_u32 s39, s39, 1
    s_cmp_eq_u32 s36, 8
    s_cbranch_scc1 L_kf_kernel_Yw1d
    s_sleep 1
    s_cmp_lt_u32 s39, 0x400000
    s_cbranch_scc1 L_kf_kernel_Yw1
L_kf_kernel_Yw1d:
    v_mfma_f32_16x16x32_bf16 v[36:39], v[148:151], v[136:139], v[36:39]
    v_mfma_f32_16x16x32_bf16 v[40:43], v[152:155], v[136:139], v[40:43]
    v_mfma_f32_16x16x32_bf16 v[44:47], v[156:159], v[136:139], v[44:47]
    v_mfma_f32_16x16x32_bf16 v[48:51], v[160:163], v[136:139], v[48:51]
    v_mfma_f32_16x16x32_bf16 v[52:55], v[164:167], v[136:139], v[52:55]
    v_mfma_f32_16x16x32_bf16 v[56:59], v[148:151], v[140:143], v[56:59]
    v_mfma_f32_16x16x32_bf16 v[60:63], v[152:155], v[140:143], v[60:63]
    v_mfma_f32_16x16x32_bf16 v[64:67], v[156:159], v[140:143], v[64:67]
    s_nop 0
    ds_write_b128 v252, v[36:39] offset:0
    v_mfma_f32_16x16x32_bf16 v[68:71], v[160:163], v[140:143], v[68:71]
    ds_write_b128 v252, v[40:43] offset:1024
    v_mfma_f32_16x16x32_bf16 v[72:75], v[164:167], v[140:143], v[72:75]
    ds_write_b128 v252, v[44:47] offset:2048
    v_mfma_f32_16x16x32_bf16 v[76:79], v[148:151], v[144:147], v[76:79]
    ds_write_b128 v252, v[48:51] offset:3072
    v_mfma_f32_16x16x32_bf16 v[80:83], v[152:155], v[144:147], v[80:83]
    ds_write_b128 v252, v[52:55] offset:4096
    v_mfma_f32_16x16x32_bf16 v[84:87], v[156:159], v[144:147], v[84:87]
    ds_write_b128 v252, v[56:59] offset:5120
    v_mfma_f32_16x16x32_bf16 v[88:91], v[160:163], v[144:147], v[88:91]
    ds_write_b128 v252, v[60:63] offset:6144
    v_mfma_f32_16x16x32_bf16 v[92:95], v[164:167], v[144:147], v[92:95]
    ds_write_b128 v252, v[64:67] offset:7168
    v_mfma_f32_16x16x32_bf16 v[16:19], v[148:151], v[132:135], v[16:19]
    ds_write_b128 v252, v[68:71] offset:8192
    v_mfma_f32_16x16x32_bf16 v[20:23], v[152:155], v[132:135], v[20:23]
    ds_write_b128 v252, v[72:75] offset:9216
    v_mfma_f32_16x16x32_bf16 v[24:27], v[156:159], v[132:135], v[24:27]
    ds_write_b128 v252, v[76:79] offset:10240
    v_mfma_f32_16x16x32_bf16 v[28:31], v[160:163], v[132:135], v[28:31]
    ds_write_b128 v252, v[80:83] offset:11264
    v_mfma_f32_16x16x32_bf16 v[32:35], v[164:167], v[132:135], v[32:35]
    ds_write_b128 v252, v[84:87] offset:12288
    ds_write_b128 v252, v[88:91] offset:13312
    ds_write_b128 v252, v[92:95] offset:14336
    v_mov_b32 v4, 161208
    v_mov_b32 v5, 1
    s_mov_b64 exec, 1
    ds_add_u32 v4, v5
    s_mov_b64 exec, -1
    s_add_u32 s36, s35, 1
    s_and_b32 s36, s36, 3
    s_mul_i32 s36, s36, 15360
    s_add_u32 s36, s36, 10240
    v_add_u32 v7, s36, v2
    s_add_u32 s36, s35, 2
    s_and_b32 s36, s36, 3
    s_mul_i32 s36, s36, 15360
    s_add_u32 s36, s36, 5120
    v_add_u32 v8, s36, v2
    s_add_u32 s36, s35, 3
    s_and_b32 s36, s36, 3
    s_mul_i32 s36, s36, 15360
    s_add_u32 s36, s36, 0
    v_add_u32 v9, s36, v2
    v_mov_b32 v4, 161208
    s_mov_b32 s39, 0
L_kf_kernel_Yw2:
    ds_read_b32 v5, v4
    s_waitcnt lgkmcnt(0)
    v_readfirstlane_b32 s36, v5
    s_add_u32 s39, s39, 1
    s_cmp_eq_u32 s36, 4
    s_cbranch_scc1 L_kf_kernel_Yw2d
    s_sleep 1
    s_cmp_lt_u32 s39, 0x400000
    s_cbranch_scc1 L_kf_kernel_Yw2
L_kf_kernel_Yw2d:
    ds_read_b128 v[96:99], v7 offset:0
    ds_read_b128 v[100:103], v8 offset:0
    ds_read_b128 v[104:107], v9 offset:0
    ds_read_b128 v[108:111], v7 offset:1024
    ds_read_b128 v[112:115], v8 offset:1024
    ds_read_b128 v[116:119], v9 offset:1024
    ds_read_b128 v[120:123], v7 offset:2048
    ds_read_b128 v[124:127], v8 offset:2048
    ds_read_b128 v[128:131], v9 offset:2048
    ds_read_b128 v[132:135], v7 offset:3072
    ds_read_b128 v[136:139], v8 offset:3072
    ds_read_b128 v[140:143], v9 offset:3072
    ds_read_b128 v[144:147], v7 offset:4096
    ds_read_b128 v[148:151], v8 offset:4096
    ds_read_b128 v[152:155], v9 offset:4096
    s_waitcnt lgkmcnt(12)
    v_add_f32 v16, v16, v96
    v_add_f32 v17, v17, v97
    v_add_f32 v18, v18, v98
    v_add_f32 v19, v19, v99
    v_add_f32 v100, v100, v104
    v_add_f32 v101, v101, v105
    v_add_f32 v102, v102, v106
    v_add_f32 v103, v103, v107
    v_add_f32 v16, v16, v100
    v_add_f32 v17, v17, v101
    v_add_f32 v18, v18, v102
    v_add_f32 v19, v19, v103
    s_waitcnt lgkmcnt(9)
    v_add_f32 v20, v20, v108
    v_add_f32 v21, v21, v109
    v_add_f32 v22, v22, v110
    v_add_f32 v23, v23, v111
    v_add_f32 v112, v112, v116
    v_add_f32 v113, v113, v117
    v_add_f32 v114, v114, v118
    v_add_f32 v115, v115, v119
    v_add_f32 v20, v20, v112
    v_add_f32 v21, v21, v113
    v_add_f32 v22, v22, v114
    v_add_f32 v23, v23, v115
    s_waitcnt lgkmcnt(6)
    v_add_f32 v24, v24, v120
    v_add_f32 v25, v25, v121
    v_add_f32 v26, v26, v122
    v_add_f32 v27, v27, v123
    v_add_f32 v124, v124, v128
    v_add_f32 v125, v125, v129
    v_add_f32 v126, v126, v130
    v_add_f32 v127, v127, v131
    v_add_f32 v24, v24, v124
    v_add_f32 v25, v25, v125
    v_add_f32 v26, v26, v126
    v_add_f32 v27, v27, v127
    s_waitcnt lgkmcnt(3)
    v_add_f32 v28, v28, v132
    v_add_f32 v29, v29, v133
    v_add_f32 v30, v30, v134
    v_add_f32 v31, v31, v135
    v_add_f32 v136, v136, v140
    v_add_f32 v137, v137, v141
    v_add_f32 v138, v138, v142
    v_add_f32 v139, v139, v143
    v_add_f32 v28, v28, v136
    v_add_f32 v29, v29, v137
    v_add_f32 v30, v30, v138
    v_add_f32 v31, v31, v139
    s_waitcnt lgkmcnt(0)
    v_add_f32 v32, v32, v144
    v_add_f32 v33, v33, v145
    v_add_f32 v34, v34, v146
    v_add_f32 v35, v35, v147
    v_add_f32 v148, v148, v152
    v_add_f32 v149, v149, v153
    v_add_f32 v150, v150, v154
    v_add_f32 v151, v151, v155
    v_add_f32 v32, v32, v148
    v_add_f32 v33, v33, v149
    v_add_f32 v34, v34, v150
    v_add_f32 v35, v35, v151
    s_mov_b32 s48, s10
    s_and_b32 s49, s11, 0xffff
    s_mov_b32 s50, 5242880
    s_mov_b32 s51, 0x00020000
    v_lshrrev_b32 v4, 2, v3
    v_lshl_add_u32 v4, v4, 2, v3
    v_add_u32 v4, s65, v4
    v_mul_u32_u24 v10, 2560, v4
    v_lshl_add_u32 v10, v1, 4, v10
    s_lshl_b32 s66, s66, 1
    s_mul_i32 s67, s35, 23552
    s_add_u32 s67, s67, 61440
    v_add_u32 v11, s67, v2
    s_lshl_b32 s38, s35, 2
    s_add_u32 s38, s38, 161216
    v_mov_b32 v4, s38
    s_mov_b32 s39, 0
L_kf_kernel_Yw3:
    ds_read_b32 v5, v4
    s_waitcnt lgkmcnt(0)
    v_readfirstlane_b32 s36, v5
    s_add_u32 s39, s39, 1
    s_cmp_eq_u32 s36, 1
    s_cbranch_scc1 L_kf_kernel_Yw3d
    s_sleep 1
    s_cmp_lt_u32 s39, 0x400000
    s_cbranch_scc1 L_kf_kernel_Yw3
L_kf_kernel_Yw3d:
    ds_read_b128 v[36:39], v11 offset:0
    ds_read_b128 v[56:59], v11 offset:5120
    ds_read_b128 v[40:43], v11 offset:1024
    ds_read_b128 v[60:63], v11 offset:6144
    ds_read_b128 v[44:47], v11 offset:2048
    ds_read_b128 v[64:67], v11 offset:7168
    ds_read_b128 v[48:51], v11 offset:3072
    ds_read_b128 v[68:71], v11 offset:8192
    ds_read_b128 v[52:55], v11 offset:4096
    ds_read_b128 v[72:75], v11 offset:9216
    s_waitcnt lgkmcnt(8)
    v_fmac_f32 v56, v16, v36
    v_fmac_f32 v57, v17, v37
    v_fmac_f32 v58, v18, v38
    v_fmac_f32 v59, v19, v39
    buffer_store_dwordx4 v[56:59], v10, s[48:51], s66 offen offset:0 nt
    s_waitcnt lgkmcnt(6)
    v_fmac_f32 v60, v20, v40
    v_fmac_f32 v61, v21, v41
    v_fmac_f32 v62, v22, v42
    v_fmac_f32 v63, v23, v43
    buffer_store_dwordx4 v[60:63], v10, s[48:51], s66 offen offset:64 nt
    s_waitcnt lgkmcnt(4)
    v_fmac_f32 v64, v24, v44
    v_fmac_f32 v65, v25, v45
    v_fmac_f32 v66, v26, v46
    v_fmac_f32 v67, v27, v47
    buffer_store_dwordx4 v[64:67], v10, s[48:51], s66 offen offset:128 nt
    s_waitcnt lgkmcnt(2)
    v_fmac_f32 v68, v28, v48
    v_fmac_f32 v69, v29, v49
    v_fmac_f32 v70, v30, v50
    v_fmac_f32 v71, v31, v51
    buffer_store_dwordx4 v[68:71], v10, s[48:51], s66 offen offset:192 nt
    s_waitcnt lgkmcnt(0)
    v_fmac_f32 v72, v32, v52
    v_fmac_f32 v73, v33, v53
    v_fmac_f32 v74, v34, v54
    v_fmac_f32 v75, v35, v55
    buffer_store_dwordx4 v[72:75], v10, s[48:51], s66 offen offset:256 nt
    s_endpgm
L_kf_kernel_M:
    s_cmp_lg_u32 s35, 3
    s_cselect_b64 vcc, -1, 0
    s_mov_b32 s48, s20
    s_and_b32 s49, s21, 0xffff
    s_mov_b32 s50, 1966080
    s_mov_b32 s51, 0x00020000
    s_mul_i32 s39, s33, 192
    s_lshl_b32 s36, s35, 8
    v_add_u32 v22, 0, v0
    v_add_u32 v22, s36, v22
    v_min_u32 v22, 767, v22
    v_mul_u32_u24 v23, 43691, v22
    v_lshrrev_b32 v23, 19, v23
    v_mul_u32_u24 v9, 12, v23
    v_sub_u32 v22, v22, v9
    v_lshlrev_b32 v22, 4, v22
    v_mul_u32_u24 v23, 3072, v23
    v_add3_u32 v1, v22, v23, s39
    v_add_u32 v22, 64, v0
    v_add_u32 v22, s36, v22
    v_min_u32 v22, 767, v22
    v_mul_u32_u24 v23, 43691, v22
    v_lshrrev_b32 v23, 19, v23
    v_mul_u32_u24 v9, 12, v23
    v_sub_u32 v22, v22, v9
    v_lshlrev_b32 v22, 4, v22
    v_mul_u32_u24 v23, 3072, v23
    v_add3_u32 v2, v22, v23, s39
    v_add_u32 v22, 128, v0
    v_add_u32 v22, s36, v22
    v_min_u32 v22, 767, v22
    v_mul_u32_u24 v23, 43691, v22
    v_lshrrev_b32 v23, 19, v23
    v_mul_u32_u24 v9, 12, v23
    v_sub_u32 v22, v22, v9
    v_lshlrev_b32 v22, 4, v22
    v_mul_u32_u24 v23, 3072, v23
    v_add3_u32 v3, v22, v23, s39
    v_add_u32 v22, 192, v0
    v_add_u32 v22, s36, v22
    v_min_u32 v22, 767, v22
    v_mul_u32_u24 v23, 43691, v22
    v_lshrrev_b32 v23, 19, v23
    v_mul_u32_u24 v9, 12, v23
    v_sub_u32 v22, v22, v9
    v_lshlrev_b32 v22, 4, v22
    v_mul_u32_u24 v23, 3072, v23
    v_add3_u32 v4, v22, v23, s39
    s_lshl_b32 s68, s35, 12
    s_add_u32 s68, s68, 26624
    s_lshl_b32 s36, s35, 1
    s_add_u32 s36, s36, 4
    s_min_u32 s36, s36, 8
    s_lshl_b32 s69, s36, 10
    s_add_u32 s69, s69, 16384
    s_and_b32 s39, s36, 1
    s_cmp_eq_u32 s39, 0
    s_cselect_b32 s40, s10, s12
    s_cselect_b32 s41, s11, s13
    s_lshr_b32 s36, s36, 1
    s_lshl_b32 s36, s36, 3
    s_mul_i32 s39, s33, 40
    s_add_u32 s36, s36, s39
    s_mul_i32 s36, s36, 1280
    s_add_u32 s40, s40, s36
    s_addc_u32 s41, s41, 0
    s_and_b32 s41, s41, 0xffff
    s_mov_b32 s42, 10240
    s_mov_b32 s43, 0x00020000
    s_lshl_b32 s36, s35, 1
    s_add_u32 s36, s36, 5
    s_min_u32 s36, s36, 9
    s_lshl_b32 s70, s36, 10
    s_add_u32 s70, s70, 16384
    s_and_b32 s39, s36, 1
    s_cmp_eq_u32 s39, 0
    s_cselect_b32 s44, s10, s12
    s_cselect_b32 s45, s11, s13
    s_lshr_b32 s36, s36, 1
    s_lshl_b32 s36, s36, 3
    s_mul_i32 s39, s33, 40
    s_add_u32 s36, s36, s39
    s_mul_i32 s36, s36, 1280
    s_add_u32 s44, s44, s36
    s_addc_u32 s45, s45, 0
    s_and_b32 s45, s45, 0xffff
    s_mov_b32 s46, 10240
    s_mov_b32 s47, 0x00020000
    v_lshrrev_b32 v22, 3, v0
    v_and_b32 v23, 7, v0
    v_xor_b32 v13, v22, v23
    v_mul_u32_u24 v5, 1280, v22
    v_lshl_add_u32 v13, v13, 4, v5
    s_cbranch_vccz L_kf_kernel_g1
    s_lshl_b32 s38, s26, 7
    s_add_u32 m0, s69, 0
    s_nop 0
    buffer_load_dwordx4 v13, s[40:43], s38 offen lds
    s_add_u32 m0, s70, 0
    s_nop 0
    buffer_load_dwordx4 v13, s[44:47], s38 offen lds
L_kf_kernel_g1:
    s_cbranch_vccz L_kf_kernel_g2
    s_mul_i32 s71, s26, 196608
    s_add_u32 m0, s68, 0
    s_nop 0
    buffer_load_dwordx4 v1, s[48:51], s71 offen lds
    s_add_u32 m0, s68, 1024
    s_nop 0
    buffer_load_dwordx4 v2, s[48:51], s71 offen lds
L_kf_kernel_g2:
    s_cbranch_vccz L_kf_kernel_g3
    s_add_u32 m0, s68, 2048
    s_nop 0
    buffer_load_dwordx4 v3, s[48:51], s71 offen lds
    s_add_u32 m0, s68, 3072
    s_nop 0
    buffer_load_dwordx4 v4, s[48:51], s71 offen lds
    s_add_u32 s26, s26, 1
    s_cmp_eq_u32 s26, 10
    s_cselect_b32 s26, 0, s26
L_kf_kernel_g3:
    s_mov_b32 s60, s28
    s_and_b32 s61, s29, 0xffff
    s_mov_b32 s62, 256
    s_mov_b32 s63, 0x00020000
    s_mul_i32 s36, s33, 22528
    s_add_u32 s36, s36, 15155200
    s_add_u32 s64, s30, s36
    s_addc_u32 s65, s31, 0
    s_and_b32 s65, s65, 0xffff
    s_mov_b32 s66, 22528
    s_mov_b32 s67, 0x00020000
    v_mov_b32 v14, 0
    v_mov_b32 v15, 0
    v_mov_b32 v18, 0x3f803f80
    v_mov_b32 v19, 0x3f803f80
    v_mov_b32 v20, 0x3f803f80
    v_mov_b32 v21, 0x3f803f80
    s_cbranch_vccnz L_kf_kernel_noclr
    v_min_u32 v8, 19, v0
    v_lshlrev_b32 v8, 2, v8
    s_mul_i32 s36, s33, 80
    v_add_u32 v8, s36, v8
    global_load_dword v1, v8, s[6:7]
    global_load_dword v2, v8, s[8:9]
    global_load_dword v3, v8, s[18:19]
    v_min_u32 v8, 47, v0
    v_lshlrev_b32 v8, 2, v8
    s_mul_i32 s36, s33, 192
    v_add_u32 v8, s36, v8
    global_load_dword v4, v8, s[22:23]
    s_add_u32 s52, s30, 15515648
    s_addc_u32 s53, s31, 0
    s_and_b32 s53, s53, 0xffff
    s_mov_b32 s54, 8192
    s_mov_b32 s55, 0x00020000
    s_lshl_b32 s36, s32, 7
    s_lshl_b32 s39, s33, 2
    s_add_u32 s36, s36, s39
    v_and_b32 v8, 1, v0
    v_lshlrev_b32 v8, 11, v8
    v_add_u32 v8, s36, v8
    s_and_b32 s36, s2, 7
    s_lshr_b32 s39, s2, 3
    s_and_b32 s26, s36, 3
    s_lshl_b32 s26, s26, 3
    s_and_b32 s27, s39, 7
    s_add_u32 s26, s26, s27
    s_lshr_b32 s27, s36, 2
    s_lshl_b32 s27, s27, 2
    s_lshr_b32 s39, s39, 3
    s_add_u32 s27, s27, s39
    s_lshl_b32 s36, s27, 7
    s_lshl_b32 s39, s26, 2
    s_add_u32 s36, s36, s39
    s_add_u32 s36, s36, 4096
    v_writelane_b32 v8, s36, 2
    s_mov_b64 exec, 7
    buffer_store_dword v14, v8, s[52:55], 0 offen sc1
    s_mov_b64 exec, -1
    v_lshlrev_b32 v8, 3, v0
    v_and_b32 v10, 15, v0
    v_lshlrev_b32 v10, 3, v10
    s_add_u32 s37, s32, 15
    s_mul_i32 s37, s37, 640
    buffer_store_dwordx2 v[14:15], v8, s[64:67], s37 offen sc1
    buffer_store_dwordx2 v[14:15], v10, s[64:67], s37 offen offset:512 sc1
    s_lshl_b32 s37, s32, 7
    s_add_u32 s37, s37, 20480
    buffer_store_dwordx2 v[14:15], v14, s[64:67], s37 offen sc1
    s_cmp_lg_u32 s32, 0
    s_cbranch_scc1 L_kf_kernel_noclr
    v_mov_b32 v10, 0
    v_mov_b32 v11, 1511506921
    s_mov_b32 s37, 0
    buffer_store_dwordx2 v[10:11], v8, s[64:67], s37 offen offset:0 sc1
    buffer_store_dwordx2 v[10:11], v8, s[64:67], s37 offen offset:512 sc1
    buffer_store_dwordx2 v[10:11], v8, s[64:67], s37 offen offset:1024 sc1
    buffer_store_dwordx2 v[10:11], v8, s[64:67], s37 offen offset:1536 sc1
    buffer_store_dwordx2 v[10:11], v8, s[64:67], s37 offen offset:2048 sc1
    buffer_store_dwordx2 v[10:11], v8, s[64:67], s37 offen offset:2560 sc1
    buffer_store_dwordx2 v[10:11], v8, s[64:67], s37 offen offset:3072 sc1
    buffer_store_dwordx2 v[10:11], v8, s[64:67], s37 offen offset:3584 sc1
    s_add_u32 s37, s37, 4096
    buffer_store_dwordx2 v[10:11], v8, s[64:67], s37 offen offset:0 sc1
    buffer_store_dwordx2 v[10:11], v8, s[64:67], s37 offen offset:512 sc1
    buffer_store_dwordx2 v[10:11], v8, s[64:67], s37 offen offset:1024 sc1
    buffer_store_dwordx2 v[10:11], v8, s[64:67], s37 offen offset:1536 sc1
    buffer_store_dwordx2 v[10:11], v8, s[64:67], s37 offen offset:2048 sc1
    buffer_store_dwordx2 v[10:11], v8, s[64:67], s37 offen offset:2560 sc1
    buffer_store_dwordx2 v[10:11], v8, s[64:67], s37 offen offset:3072 sc1
    buffer_store_dwordx2 v[10:11], v8, s[64:67], s37 offen offset:3584 sc1
    s_add_u32 s37, s37, 4096
    buffer_store_dwordx2 v[10:11], v8, s[64:67], s37 offen offset:0 sc1
    buffer_store_dwordx2 v[10:11], v8, s[64:67], s37 offen offset:512 sc1
    v_min_u32 v8, 376, v8
    buffer_store_dwordx2 v[10:11], v8, s[64:67], s37 offen offset:1024 sc1
L_kf_kernel_noclr:
    v_and_b32 v22, 15, v0
    v_bfe_u32 v23, v0, 4, 1
    v_lshrrev_b32 v72, 2, v22
    v_and_b32 v73, 3, v22
    v_lshlrev_b32 v74, 3, v72
    v_lshl_add_u32 v74, v23, 2, v74
    v_add_u32 v74, v74, v73
    s_lshl_b32 s36, s35, 5
    v_add_u32 v77, s36, v74
    v_lshlrev_b32 v74, 7, v77
    v_lshrrev_b32 v75, 1, v72
    v_lshlrev_b32 v75, 2, v75
    v_and_b32 v76, 2, v73
    v_or3_b32 v75, v75, v76, v23
    v_lshrrev_b32 v76, 5, v0
    v_xor_b32 v75, v75, v76
    v_lshlrev_b32 v78, 3, v76
    v_bfe_u32 v79, v0, 2, 2
    v_add_u32 v78, v78, v79
    v_mul_u32_u24 v78, 192, v78
    v_lshl_add_u32 v78, v23, 5, v78
    v_and_b32 v79, 3, v0
    v_lshl_add_u32 v78, v79, 3, v78
    v_add_u32 v78, 26624, v78
    v_xor_b32 v79, v23, v0
    v_and_b32 v79, 1, v79
    v_add_u32 v79, -1, v79
    v_and_b32 v252, 0x3f803f80, v79
    v_mov_b32 v253, v252
    v_mov_b32 v254, v252
    v_mov_b32 v255, v252
    v_xor_b32 v76, 0, v75
    v_lshl_add_u32 v5, v76, 4, v74
    v_xor_b32 v76, 2, v75
    v_lshl_add_u32 v6, v76, 4, v74
    v_xor_b32 v76, 4, v75
    v_lshl_add_u32 v7, v76, 4, v74
    v_xor_b32 v76, 6, v75
    v_lshl_add_u32 v8, v76, 4, v74
    s_add_u32 s36, s35, 0
    s_sub_u32 s39, s36, 3
    s_cmp_ge_u32 s36, 3
    s_cselect_b32 s4, s39, s36
    s_lshl_b32 s39, s4, 6
    v_add_u32 v9, s39, v78
    s_add_u32 s36, s35, 1
    s_sub_u32 s39, s36, 3
    s_cmp_ge_u32 s36, 3
    s_cselect_b32 s5, s39, s36
    s_lshl_b32 s39, s5, 6
    v_add_u32 v10, s39, v78
    s_add_u32 s36, s35, 2
    s_sub_u32 s39, s36, 3
    s_cmp_ge_u32 s36, 3
    s_cselect_b32 s6, s39, s36
    s_lshl_b32 s39, s6, 6
    v_add_u32 v11, s39, v78
    v_lshlrev_b32 v23, 3, v77
    s_mov_b32 s52, s22
    s_and_b32 s53, s23, 0xffff
    s_mov_b32 s54, 3072
    s_mov_b32 s55, 0x00020000
    v_lshrrev_b32 v72, 4, v0
    s_and_b32 s36, s35, 1
    s_lshl_b32 s36, s36, 2
    v_add_u32 v72, s36, v72
    v_and_b32 v73, 7, v0
    v_xor_b32 v72, v72, v73
    v_lshlrev_b32 v73, 7, v22
    v_lshl_add_u32 v16, v72, 4, v73
    v_add_u32 v16, 16384, v16
    v_lshlrev_b32 v72, 3, v0
    v_add_u32 v72, 160768, v72
    ds_write_b64 v72, v[14:15]
    v_mov_b32 v200, 0
    v_mov_b32 v201, 0
    v_mov_b32 v202, 0
    v_mov_b32 v203, 0
    v_mov_b32 v204, 0
    v_mov_b32 v205, 0
    v_mov_b32 v206, 0
    v_mov_b32 v207, 0
    v_mov_b32 v208, 0
    v_mov_b32 v209, 0
    v_mov_b32 v210, 0
    v_mov_b32 v211, 0
    v_mov_b32 v212, 0
    v_mov_b32 v213, 0
    v_mov_b32 v214, 0
    v_mov_b32 v215, 0
    v_mov_b32 v216, 0
    v_mov_b32 v217, 0
    v_mov_b32 v218, 0
    v_mov_b32 v219, 0
    s_lshr_b32 s37, s35, 1
    s_cbranch_vccz L_kf_kernel_g4
    s_lshl_b32 s38, s26, 7
    s_add_u32 m0, s69, 38912
    s_nop 0
    buffer_load_dwordx4 v13, s[40:43], s38 offen lds
    s_add_u32 m0, s70, 38912
    s_nop 0
    buffer_load_dwordx4 v13, s[44:47], s38 offen lds
L_kf_kernel_g4:
    s_cbranch_vccz L_kf_kernel_g5
    s_mul_i32 s71, s26, 196608
    s_add_u32 m0, s68, 38912
    s_nop 0
    buffer_load_dwordx4 v1, s[48:51], s71 offen lds
    s_add_u32 m0, s68, 39936
    s_nop 0
    buffer_load_dwordx4 v2, s[48:51], s71 offen lds
L_kf_kernel_g5:
    s_cbranch_vccz L_kf_kernel_g6
    s_add_u32 m0, s68, 40960
    s_nop 0
    buffer_load_dwordx4 v3, s[48:51], s71 offen lds
    s_add_u32 m0, s68, 41984
    s_nop 0
    buffer_load_dwordx4 v4, s[48:51], s71 offen lds
    s_add_u32 s26, s26, 1
    s_cmp_eq_u32 s26, 10
    s_cselect_b32 s26, 0, s26
L_kf_kernel_g6:
    s_cbranch_vccz L_kf_kernel_g7
    s_waitcnt vmcnt(6)
L_kf_kernel_g7:
    s_waitcnt lgkmcnt(0)
    s_barrier
    s_cmp_lg_u32 s37, 0
    s_cbranch_scc1 L_kf_kernel_cs0a
    ds_read_b128 v[220:223], v16 offset:0
    ds_read_b128 v[224:227], v16 offset:2048
    ds_read_b128 v[228:231], v16 offset:4096
    ds_read_b128 v[232:235], v16 offset:6144
    ds_read_b128 v[236:239], v16 offset:8192
L_kf_kernel_cs0a:
    v_add_u32 v16, 38912, v16
    ds_read_b128 v[72:75], v5
    ds_read_b64_tr_b16 v[104:105], v9 offset:0
    ds_read_b64_tr_b16 v[106:107], v9 offset:768
    ds_read_b64_tr_b16 v[108:109], v10 offset:0
    ds_read_b64_tr_b16 v[110:111], v10 offset:768
    ds_read_b64_tr_b16 v[112:113], v11 offset:0
    ds_read_b64_tr_b16 v[114:115], v11 offset:768
    ds_read_b128 v[76:79], v6
    ds_read_b64_tr_b16 v[116:117], v9 offset:3072
    ds_read_b64_tr_b16 v[118:119], v9 offset:3840
    ds_read_b64_tr_b16 v[120:121], v10 offset:3072
    ds_read_b64_tr_b16 v[122:123], v10 offset:3840
    ds_read_b64_tr_b16 v[124:125], v11 offset:3072
    ds_read_b64_tr_b16 v[126:127], v11 offset:3840
    ds_read_b128 v[80:83], v7
    ds_read_b64_tr_b16 v[128:129], v9 offset:6144
    ds_read_b64_tr_b16 v[130:131], v9 offset:6912
    ds_read_b64_tr_b16 v[132:133], v10 offset:6144
    ds_read_b64_tr_b16 v[134:135], v10 offset:6912
    ds_read_b64_tr_b16 v[136:137], v11 offset:6144
    ds_read_b64_tr_b16 v[138:139], v11 offset:6912
    ds_read_b128 v[84:87], v8
    ds_read_b64_tr_b16 v[140:141], v9 offset:9216
    ds_read_b64_tr_b16 v[142:143], v9 offset:9984
    ds_read_b64_tr_b16 v[144:145], v10 offset:9216
    ds_read_b64_tr_b16 v[146:147], v10 offset:9984
    ds_read_b64_tr_b16 v[148:149], v11 offset:9216
    ds_read_b64_tr_b16 v[150:151], v11 offset:9984
    v_add_u32 v5, 38912, v5
    v_add_u32 v6, 38912, v6
    v_add_u32 v7, 38912, v7
    v_add_u32 v8, 38912, v8
    v_add_u32 v9, 38912, v9
    v_add_u32 v10, 38912, v10
    v_add_u32 v11, 38912, v11
    s_cbranch_vccz L_kf_kernel_g11
    s_lshl_b32 s38, s26, 7
    s_add_u32 m0, s69, 77824
    s_nop 0
    buffer_load_dwordx4 v13, s[40:43], s38 offen lds
    s_add_u32 m0, s70, 77824
    s_nop 0
    buffer_load_dwordx4 v13, s[44:47], s38 offen lds
L_kf_kernel_g11:
    s_cbranch_vccz L_kf_kernel_g12
    s_mul_i32 s71, s26, 196608
    s_add_u32 m0, s68, 77824
    s_nop 0
    buffer_load_dwordx4 v1, s[48:51], s71 offen lds
    s_add_u32 m0, s68, 78848
    s_nop 0
    buffer_load_dwordx4 v2, s[48:51], s71 offen lds
L_kf_kernel_g12:
    s_cbranch_vccz L_kf_kernel_g13
    s_add_u32 m0, s68, 79872
    s_nop 0
    buffer_load_dwordx4 v3, s[48:51], s71 offen lds
    s_add_u32 m0, s68, 80896
    s_nop 0
    buffer_load_dwordx4 v4, s[48:51], s71 offen lds
    s_add_u32 s26, s26, 1
    s_cmp_eq_u32 s26, 10
    s_cselect_b32 s26, 0, s26
L_kf_kernel_g13:
    s_waitcnt lgkmcnt(0)
    s_cmp_lg_u32 s37, 0
    s_cbranch_scc1 L_kf_kernel_cs0b
    v_mfma_f32_16x16x32_bf16 v[200:203], v[18:21], v[220:223], v[200:203]
    v_mfma_f32_16x16x32_bf16 v[204:207], v[18:21], v[224:227], v[204:207]
    v_mfma_f32_16x16x32_bf16 v[208:211], v[18:21], v[228:231], v[208:211]
    v_mfma_f32_16x16x32_bf16 v[212:215], v[18:21], v[232:235], v[212:215]
    v_mfma_f32_16x16x32_bf16 v[216:219], v[18:21], v[236:239], v[216:219]
L_kf_kernel_cs0b:
    s_cbranch_vccz L_kf_kernel_g14
    s_waitcnt vmcnt(6)
L_kf_kernel_g14:
    s_cbranch_vccnz L_kf_kernel_w7
    s_waitcnt vmcnt(0)
    v_min_u32 v17, 19, v0
    v_lshlrev_b32 v17, 2, v17
    v_add_u32 v17, 155648, v17
    ds_write_b32 v17, v1
    ds_write_b32 v17, v2 offset:128
    ds_write_b32 v17, v3 offset:256
L_kf_kernel_w7:
    s_barrier
    s_cmp_lg_u32 s37, 1
    s_cbranch_scc1 L_kf_kernel_cs1a
    ds_read_b128 v[220:223], v16 offset:0
    ds_read_b128 v[224:227], v16 offset:2048
    ds_read_b128 v[228:231], v16 offset:4096
    ds_read_b128 v[232:235], v16 offset:6144
    ds_read_b128 v[236:239], v16 offset:8192
L_kf_kernel_cs1a:
    v_add_u32 v16, 38912, v16
    v_mfma_f32_16x16x32_bf16 v[240:243], v[104:107], v[252:255], 0
    ds_read_b128 v[88:91], v5
    s_cbranch_vccz L_kf_kernel_g18
    s_lshl_b32 s38, s26, 7
    s_add_u32 m0, s69, 116736
    s_nop 0
    buffer_load_dwordx4 v13, s[40:43], s38 offen lds
    s_add_u32 m0, s70, 116736
    s_nop 0
    buffer_load_dwordx4 v13, s[44:47], s38 offen lds
L_kf_kernel_g18:
    v_mfma_f32_16x16x32_bf16 v[244:247], v[116:119], v[252:255], 0
    ds_read_b64_tr_b16 v[152:153], v9 offset:0
    ds_read_b64_tr_b16 v[154:155], v9 offset:768
    ds_read_b64_tr_b16 v[156:157], v10 offset:0
    ds_read_b64_tr_b16 v[158:159], v10 offset:768
    v_mfma_f32_16x16x32_bf16 v[240:243], v[128:131], v[252:255], v[240:243]
    s_cbranch_vccz L_kf_kernel_g19
    s_mul_i32 s71, s26, 196608
    s_add_u32 m0, s68, 116736
    s_nop 0
    buffer_load_dwordx4 v1, s[48:51], s71 offen lds
    s_add_u32 m0, s68, 117760
    s_nop 0
    buffer_load_dwordx4 v2, s[48:51], s71 offen lds
L_kf_kernel_g19:
    v_mfma_f32_16x16x32_bf16 v[244:247], v[140:143], v[252:255], v[244:247]
    ds_read_b64_tr_b16 v[160:161], v11 offset:0
    ds_read_b64_tr_b16 v[162:163], v11 offset:768
    ds_read_b128 v[92:95], v6
    v_mfma_f32_32x32x16_bf16 v[24:39], v[104:107], v[72:75], 0
    ds_read_b64_tr_b16 v[164:165], v9 offset:3072
    ds_read_b64_tr_b16 v[166:167], v9 offset:3840
    s_cbranch_vccz L_kf_kernel_g20
    s_add_u32 m0, s68, 118784
    s_nop 0
    buffer_load_dwordx4 v3, s[48:51], s71 offen lds
    s_add_u32 m0, s68, 119808
    s_nop 0
    buffer_load_dwordx4 v4, s[48:51], s71 offen lds
    s_add_u32 s26, s26, 1
    s_cmp_eq_u32 s26, 10
    s_cselect_b32 s26, 0, s26
L_kf_kernel_g20:
    v_mfma_f32_32x32x16_bf16 v[40:55], v[108:111], v[72:75], 0
    ds_read_b64_tr_b16 v[168:169], v10 offset:3072
    ds_read_b64_tr_b16 v[170:171], v10 offset:3840
    v_mfma_f32_32x32x16_bf16 v[56:71], v[112:115], v[72:75], 0
    ds_read_b64_tr_b16 v[172:173], v11 offset:3072
    ds_read_b64_tr_b16 v[174:175], v11 offset:3840
    ds_read_b128 v[96:99], v7
    v_mfma_f32_32x32x16_bf16 v[24:39], v[116:119], v[76:79], v[24:39]
    s_cbranch_vccz L_kf_kernel_g15
    s_lshl_b32 s38, s26, 7
    s_add_u32 m0, s69, 0
    s_nop 0
    buffer_load_dwordx4 v13, s[40:43], s38 offen lds
    s_add_u32 m0, s70, 0
    s_nop 0
    buffer_load_dwordx4 v13, s[44:47], s38 offen lds
L_kf_kernel_g15:
    ds_read_b64_tr_b16 v[176:177], v9 offset:6144
    ds_read_b64_tr_b16 v[178:179], v9 offset:6912
    v_mfma_f32_32x32x16_bf16 v[40:55], v[120:123], v[76:79], v[40:55]
    ds_read_b64_tr_b16 v[180:181], v10 offset:6144
    ds_read_b64_tr_b16 v[182:183], v10 offset:6912
    v_mfma_f32_32x32x16_bf16 v[56:71], v[124:127], v[76:79], v[56:71]
    ds_read_b64_tr_b16 v[184:185], v11 offset:6144
    ds_read_b64_tr_b16 v[186:187], v11 offset:6912
    s_cbranch_vccz L_kf_kernel_g16
    s_mul_i32 s71, s26, 196608
    s_add_u32 m0, s68, 0
    s_nop 0
    buffer_load_dwordx4 v1, s[48:51], s71 offen lds
    s_add_u32 m0, s68, 1024
    s_nop 0
    buffer_load_dwordx4 v2, s[48:51], s71 offen lds
L_kf_kernel_g16:
    v_mfma_f32_32x32x16_bf16 v[24:39], v[128:131], v[80:83], v[24:39]
    ds_read_b128 v[100:103], v8
    ds_read_b64_tr_b16 v[188:189], v9 offset:9216
    ds_read_b64_tr_b16 v[190:191], v9 offset:9984
    v_mfma_f32_32x32x16_bf16 v[40:55], v[132:135], v[80:83], v[40:55]
    ds_read_b64_tr_b16 v[192:193], v10 offset:9216
    ds_read_b64_tr_b16 v[194:195], v10 offset:9984
    v_mfma_f32_32x32x16_bf16 v[56:71], v[136:139], v[80:83], v[56:71]
    s_cbranch_vccz L_kf_kernel_g17
    s_add_u32 m0, s68, 2048
    s_nop 0
    buffer_load_dwordx4 v3, s[48:51], s71 offen lds
    s_add_u32 m0, s68, 3072
    s_nop 0
    buffer_load_dwordx4 v4, s[48:51], s71 offen lds
    s_add_u32 s26, s26, 1
    s_cmp_eq_u32 s26, 10
    s_cselect_b32 s26, 0, s26
L_kf_kernel_g17:
    ds_read_b64_tr_b16 v[196:197], v11 offset:9216
    ds_read_b64_tr_b16 v[198:199], v11 offset:9984
    v_mfma_f32_32x32x16_bf16 v[24:39], v[140:143], v[84:87], v[24:39]
    v_add_u32 v5, 38912, v5
    v_add_u32 v6, 38912, v6
    v_add_u32 v7, 38912, v7
    v_add_u32 v8, 38912, v8
    v_add_u32 v9, 38912, v9
    v_add_u32 v10, 38912, v10
    v_add_u32 v11, 38912, v11
    v_mfma_f32_32x32x16_bf16 v[40:55], v[144:147], v[84:87], v[40:55]
    v_mfma_f32_32x32x16_bf16 v[56:71], v[148:151], v[84:87], v[56:71]
    s_cbranch_vccnz L_kf_kernel_na
    s_waitcnt vmcnt(0)
    s_lshl_b32 s36, s33, 4
    v_mov_b32 v14, s36
    v_mov_b32 v15, 1
    s_mov_b64 exec, 1
    buffer_atomic_add v15, v14, s[60:63], 0 offen sc0
    s_mov_b64 exec, -1
L_kf_kernel_na:
    s_waitcnt lgkmcnt(0)
    s_cmp_lg_u32 s37, 1
    s_cbranch_scc1 L_kf_kernel_cs1b
    v_mfma_f32_16x16x32_bf16 v[200:203], v[18:21], v[220:223], v[200:203]
    v_mfma_f32_16x16x32_bf16 v[204:207], v[18:21], v[224:227], v[204:207]
    v_mfma_f32_16x16x32_bf16 v[208:211], v[18:21], v[228:231], v[208:211]
    v_mfma_f32_16x16x32_bf16 v[212:215], v[18:21], v[232:235], v[212:215]
    v_mfma_f32_16x16x32_bf16 v[216:219], v[18:21], v[236:239], v[216:219]
L_kf_kernel_cs1b:
    s_cbranch_vccz L_kf_kernel_g21
    s_waitcnt vmcnt(12)
L_kf_kernel_g21:
    s_barrier
    s_cmp_lg_u32 s37, 0
    s_cbranch_scc1 L_kf_kernel_cs2a
    ds_read_b128 v[220:223], v16 offset:0
    ds_read_b128 v[224:227], v16 offset:2048
    ds_read_b128 v[228:231], v16 offset:4096
    ds_read_b128 v[232:235], v16 offset:6144
    ds_read_b128 v[236:239], v16 offset:8192
L_kf_kernel_cs2a:
    v_add_u32 v16, 38912, v16
    v_mfma_f32_16x16x32_bf16 v[240:243], v[152:155], v[252:255], v[240:243]
    ds_read_b128 v[72:75], v5
    s_cbranch_vccz L_kf_kernel_g22
    s_lshl_b32 s38, s26, 7
    s_add_u32 m0, s69, 38912
    s_nop 0
    buffer_load_dwordx4 v13, s[40:43], s38 offen lds
    s_add_u32 m0, s70, 38912
    s_nop 0
    buffer_load_dwordx4 v13, s[44:47], s38 offen lds
L_kf_kernel_g22:
    v_mfma_f32_16x16x32_bf16 v[244:247], v[164:167], v[252:255], v[244:247]
    ds_read_b64_tr_b16 v[104:105], v9 offset:0
    ds_read_b64_tr_b16 v[106:107], v9 offset:768
    v_mfma_f32_16x16x32_bf16 v[240:243], v[176:179], v[252:255], v[240:243]
    ds_read_b64_tr_b16 v[108:109], v10 offset:0
    ds_read_b64_tr_b16 v[110:111], v10 offset:768
    ds_read_b64_tr_b16 v[112:113], v11 offset:0
    ds_read_b64_tr_b16 v[114:115], v11 offset:768
    v_mfma_f32_16x16x32_bf16 v[244:247], v[188:191], v[252:255], v[244:247]
    ds_read_b128 v[76:79], v6
    v_mfma_f32_32x32x16_bf16 v[24:39], v[152:155], v[88:91], v[24:39]
    ds_read_b64_tr_b16 v[116:117], v9 offset:3072
    ds_read_b64_tr_b16 v[118:119], v9 offset:3840
    s_cbranch_vccz L_kf_kernel_g23
    s_mul_i32 s71, s26, 196608
    s_add_u32 m0, s68, 38912
    s_nop 0
    buffer_load_dwordx4 v1, s[48:51], s71 offen lds
    s_add_u32 m0, s68, 39936
    s_nop 0
    buffer_load_dwordx4 v2, s[48:51], s71 offen lds
L_kf_kernel_g23:
    v_mfma_f32_32x32x16_bf16 v[40:55], v[156:159], v[88:91], v[40:55]
    ds_read_b64_tr_b16 v[120:121], v10 offset:3072
    ds_read_b64_tr_b16 v[122:123], v10 offset:3840
    v_mfma_f32_32x32x16_bf16 v[56:71], v[160:163], v[88:91], v[56:71]
    ds_read_b64_tr_b16 v[124:125], v11 offset:3072
    ds_read_b64_tr_b16 v[126:127], v11 offset:3840
    v_mfma_f32_32x32x16_bf16 v[24:39], v[164:167], v[92:95], v[24:39]
    ds_read_b128 v[80:83], v7
    ds_read_b64_tr_b16 v[128:129], v9 offset:6144
    ds_read_b64_tr_b16 v[130:131], v9 offset:6912
    v_mfma_f32_32x32x16_bf16 v[40:55], v[168:171], v[92:95], v[40:55]
    ds_read_b64_tr_b16 v[132:133], v10 offset:6144
    ds_read_b64_tr_b16 v[134:135], v10 offset:6912
    v_mfma_f32_32x32x16_bf16 v[56:71], v[172:175], v[92:95], v[56:71]
    ds_read_b64_tr_b16 v[136:137], v11 offset:6144
    ds_read_b64_tr_b16 v[138:139], v11 offset:6912
    s_cbranch_vccz L_kf_kernel_g24
    s_add_u32 m0, s68, 40960
    s_nop 0
    buffer_load_dwordx4 v3, s[48:51], s71 offen lds
    s_add_u32 m0, s68, 41984
    s_nop 0
    buffer_load_dwordx4 v4, s[48:51], s71 offen lds
    s_add_u32 s26, s26, 1
    s_cmp_eq_u32 s26, 10
    s_cselect_b32 s26, 0, s26
L_kf_kernel_g24:
    v_mfma_f32_32x32x16_bf16 v[24:39], v[176:179], v[96:99], v[24:39]
    ds_read_b128 v[84:87], v8
    v_mfma_f32_32x32x16_bf16 v[40:55], v[180:183], v[96:99], v[40:55]
    ds_read_b64_tr_b16 v[140:141], v9 offset:9216
    ds_read_b64_tr_b16 v[142:143], v9 offset:9984
    ds_read_b64_tr_b16 v[144:145], v10 offset:9216
    ds_read_b64_tr_b16 v[146:147], v10 offset:9984
    v_mfma_f32_32x32x16_bf16 v[56:71], v[184:187], v[96:99], v[56:71]
    ds_read_b64_tr_b16 v[148:149], v11 offset:9216
    ds_read_b64_tr_b16 v[150:151], v11 offset:9984
    v_mfma_f32_32x32x16_bf16 v[24:39], v[188:191], v[100:103], v[24:39]
    v_add_u32 v5, 38912, v5
    v_add_u32 v6, 38912, v6
    v_add_u32 v7, 38912, v7
    v_add_u32 v8, 38912, v8
    v_add_u32 v9, 38912, v9
    v_add_u32 v10, 38912, v10
    v_add_u32 v11, 38912, v11
    v_mfma_f32_32x32x16_bf16 v[40:55], v[192:195], v[100:103], v[40:55]
    v_mfma_f32_32x32x16_bf16 v[56:71], v[196:199], v[100:103], v[56:71]
    s_waitcnt lgkmcnt(0)
    s_cmp_lg_u32 s37, 0
    s_cbranch_scc1 L_kf_kernel_cs2b
    v_mfma_f32_16x16x32_bf16 v[200:203], v[18:21], v[220:223], v[200:203]
    v_mfma_f32_16x16x32_bf16 v[204:207], v[18:21], v[224:227], v[204:207]
    v_mfma_f32_16x16x32_bf16 v[208:211], v[18:21], v[228:231], v[208:211]
    v_mfma_f32_16x16x32_bf16 v[212:215], v[18:21], v[232:235], v[212:215]
    v_mfma_f32_16x16x32_bf16 v[216:219], v[18:21], v[236:239], v[216:219]
L_kf_kernel_cs2b:
    s_cbranch_vccz L_kf_kernel_g25
    s_waitcnt vmcnt(12)
L_kf_kernel_g25:
    s_barrier
    s_cmp_lg_u32 s37, 1
    s_cbranch_scc1 L_kf_kernel_cs3a
    ds_read_b128 v[220:223], v16 offset:0
    ds_read_b128 v[224:227], v16 offset:2048
    ds_read_b128 v[228:231], v16 offset:4096
    ds_read_b128 v[232:235], v16 offset:6144
    ds_read_b128 v[236:239], v16 offset:8192
L_kf_kernel_cs3a:
    v_add_u32 v16, 4294850560, v16
    v_mfma_f32_16x16x32_bf16 v[240:243], v[104:107], v[252:255], v[240:243]
    ds_read_b128 v[88:91], v5
    s_cbranch_vccz L_kf_kernel_g26
    s_lshl_b32 s38, s26, 7
    s_add_u32 m0, s69, 77824
    s_nop 0
    buffer_load_dwordx4 v13, s[40:43], s38 offen lds
    s_add_u32 m0, s70, 77824
    s_nop 0
    buffer_load_dwordx4 v13, s[44:47], s38 offen lds
L_kf_kernel_g26:
    v_mfma_f32_16x16x32_bf16 v[244:247], v[116:119], v[252:255], v[244:247]
    ds_read_b64_tr_b16 v[152:153], v9 offset:0
    ds_read_b64_tr_b16 v[154:155], v9 offset:768
    v_mfma_f32_16x16x32_bf16 v[240:243], v[128:131], v[252:255], v[240:243]
    ds_read_b64_tr_b16 v[156:157], v10 offset:0
    ds_read_b64_tr_b16 v[158:159], v10 offset:768
    ds_read_b64_tr_b16 v[160:161], v11 offset:0
    ds_read_b64_tr_b16 v[162:163], v11 offset:768
    v_mfma_f32_16x16x32_bf16 v[244:247], v[140:143], v[252:255], v[244:247]
    ds_read_b128 v[92:95], v6
    v_mfma_f32_32x32x16_bf16 v[24:39], v[104:107], v[72:75], v[24:39]
    ds_read_b64_tr_b16 v[164:165], v9 offset:3072
    ds_read_b64_tr_b16 v[166:167], v9 offset:3840
    s_cbranch_vccz L_kf_kernel_g27
    s_mul_i32 s71, s26, 196608
    s_add_u32 m0, s68, 77824
    s_nop 0
    buffer_load_dwordx4 v1, s[48:51], s71 offen lds
    s_add_u32 m0, s68, 78848
    s_nop 0
    buffer_load_dwordx4 v2, s[48:51], s71 offen lds
L_kf_kernel_g27:
    v_mfma_f32_32x32x16_bf16 v[40:55], v[108:111], v[72:75], v[40:55]
    ds_read_b64_tr_b16 v[168:169], v10 offset:3072
    ds_read_b64_tr_b16 v[170:171], v10 offset:3840
    v_mfma_f32_32x32x16_bf16 v[56:71], v[112:115], v[72:75], v[56:71]
    ds_read_b64_tr_b16 v[172:173], v11 offset:3072
    ds_read_b64_tr_b16 v[174:175], v11 offset:3840
    v_mfma_f32_32x32x16_bf16 v[24:39], v[116:119], v[76:79], v[24:39]
    ds_read_b128 v[96:99], v7
    ds_read_b64_tr_b16 v[176:177], v9 offset:6144
    ds_read_b64_tr_b16 v[178:179], v9 offset:6912
    v_mfma_f32_32x32x16_bf16 v[40:55], v[120:123], v[76:79], v[40:55]
    ds_read_b64_tr_b16 v[180:181], v10 offset:6144
    ds_read_b64_tr_b16 v[182:183], v10 offset:6912
    v_mfma_f32_32x32x16_bf16 v[56:71], v[124:127], v[76:79], v[56:71]
    ds_read_b64_tr_b16 v[184:185], v11 offset:6144
    ds_read_b64_tr_b16 v[186:187], v11 offset:6912
    s_cbranch_vccz L_kf_kernel_g28
    s_add_u32 m0, s68, 79872
    s_nop 0
    buffer_load_dwordx4 v3, s[48:51], s71 offen lds
    s_add_u32 m0, s68, 80896
    s_nop 0
    buffer_load_dwordx4 v4, s[48:51], s71 offen lds
    s_add_u32 s26, s26, 1
    s_cmp_eq_u32 s26, 10
    s_cselect_b32 s26, 0, s26
L_kf_kernel_g28:
    v_mfma_f32_32x32x16_bf16 v[24:39], v[128:131], v[80:83], v[24:39]
    ds_read_b128 v[100:103], v8
    v_mfma_f32_32x32x16_bf16 v[40:55], v[132:135], v[80:83], v[40:55]
    ds_read_b64_tr_b16 v[188:189], v9 offset:9216
    ds_read_b64_tr_b16 v[190:191], v9 offset:9984
    ds_read_b64_tr_b16 v[192:193], v10 offset:9216
    ds_read_b64_tr_b16 v[194:195], v10 offset:9984
    v_mfma_f32_32x32x16_bf16 v[56:71], v[136:139], v[80:83], v[56:71]
    ds_read_b64_tr_b16 v[196:197], v11 offset:9216
    ds_read_b64_tr_b16 v[198:199], v11 offset:9984
    v_mfma_f32_32x32x16_bf16 v[24:39], v[140:143], v[84:87], v[24:39]
    v_add_u32 v5, 4294850560, v5
    v_add_u32 v6, 4294850560, v6
    v_add_u32 v7, 4294850560, v7
    v_add_u32 v8, 4294850560, v8
    v_add_u32 v9, 4294850560, v9
    v_add_u32 v10, 4294850560, v10
    v_add_u32 v11, 4294850560, v11
    v_mfma_f32_32x32x16_bf16 v[40:55], v[144:147], v[84:87], v[40:55]
    v_mfma_f32_32x32x16_bf16 v[56:71], v[148:151], v[84:87], v[56:71]
    s_waitcnt lgkmcnt(0)
    s_cmp_lg_u32 s37, 1
    s_cbranch_scc1 L_kf_kernel_cs3b
    v_mfma_f32_16x16x32_bf16 v[200:203], v[18:21], v[220:223], v[200:203]
    v_mfma_f32_16x16x32_bf16 v[204:207], v[18:21], v[224:227], v[204:207]
    v_mfma_f32_16x16x32_bf16 v[208:211], v[18:21], v[228:231], v[208:211]
    v_mfma_f32_16x16x32_bf16 v[212:215], v[18:21], v[232:235], v[212:215]
    v_mfma_f32_16x16x32_bf16 v[216:219], v[18:21], v[236:239], v[216:219]
L_kf_kernel_cs3b:
    s_cbranch_vccz L_kf_kernel_g29
    s_waitcnt vmcnt(12)
L_kf_kernel_g29:
    s_barrier
    s_cmp_lg_u32 s37, 0
    s_cbranch_scc1 L_kf_kernel_cs4a
    ds_read_b128 v[220:223], v16 offset:0
    ds_read_b128 v[224:227], v16 offset:2048
    ds_read_b128 v[228:231], v16 offset:4096
    ds_read_b128 v[232:235], v16 offset:6144
    ds_read_b128 v[236:239], v16 offset:8192
L_kf_kernel_cs4a:
    v_add_u32 v16, 38912, v16
    v_mfma_f32_16x16x32_bf16 v[240:243], v[152:155], v[252:255], v[240:243]
    ds_read_b128 v[72:75], v5
    s_cbranch_vccz L_kf_kernel_g30
    s_lshl_b32 s38, s26, 7
    s_add_u32 m0, s69, 116736
    s_nop 0
    buffer_load_dwordx4 v13, s[40:43], s38 offen lds
    s_add_u32 m0, s70, 116736
    s_nop 0
    buffer_load_dwordx4 v13, s[44:47], s38 offen lds
L_kf_kernel_g30:
    v_mfma_f32_16x16x32_bf16 v[244:247], v[164:167], v[252:255], v[244:247]
    ds_read_b64_tr_b16 v[104:105], v9 offset:0
    ds_read_b64_tr_b16 v[106:107], v9 offset:768
    v_mfma_f32_16x16x32_bf16 v[240:243], v[176:179], v[252:255], v[240:243]
    ds_read_b64_tr_b16 v[108:109], v10 offset:0
    ds_read_b64_tr_b16 v[110:111], v10 offset:768
    ds_read_b64_tr_b16 v[112:113], v11 offset:0
    ds_read_b64_tr_b16 v[114:115], v11 offset:768
    v_mfma_f32_16x16x32_bf16 v[244:247], v[188:191], v[252:255], v[244:247]
    ds_read_b128 v[76:79], v6
    v_mfma_f32_32x32x16_bf16 v[24:39], v[152:155], v[88:91], v[24:39]
    ds_read_b64_tr_b16 v[116:117], v9 offset:3072
    ds_read_b64_tr_b16 v[118:119], v9 offset:3840
    s_cbranch_vccz L_kf_kernel_g31
    s_mul_i32 s71, s26, 196608
    s_add_u32 m0, s68, 116736
    s_nop 0
    buffer_load_dwordx4 v1, s[48:51], s71 offen lds
    s_add_u32 m0, s68, 117760
    s_nop 0
    buffer_load_dwordx4 v2, s[48:51], s71 offen lds
L_kf_kernel_g31:
    v_mfma_f32_32x32x16_bf16 v[40:55], v[156:159], v[88:91], v[40:55]
    ds_read_b64_tr_b16 v[120:121], v10 offset:3072
    ds_read_b64_tr_b16 v[122:123], v10 offset:3840
    v_mfma_f32_32x32x16_bf16 v[56:71], v[160:163], v[88:91], v[56:71]
    ds_read_b64_tr_b16 v[124:125], v11 offset:3072
    ds_read_b64_tr_b16 v[126:127], v11 offset:3840
    v_mfma_f32_32x32x16_bf16 v[24:39], v[164:167], v[92:95], v[24:39]
    ds_read_b128 v[80:83], v7
    ds_read_b64_tr_b16 v[128:129], v9 offset:6144
    ds_read_b64_tr_b16 v[130:131], v9 offset:6912
    v_mfma_f32_32x32x16_bf16 v[40:55], v[168:171], v[92:95], v[40:55]
    ds_read_b64_tr_b16 v[132:133], v10 offset:6144
    ds_read_b64_tr_b16 v[134:135], v10 offset:6912
    v_mfma_f32_32x32x16_bf16 v[56:71], v[172:175], v[92:95], v[56:71]
    ds_read_b64_tr_b16 v[136:137], v11 offset:6144
    ds_read_b64_tr_b16 v[138:139], v11 offset:6912
    s_cbranch_vccz L_kf_kernel_g32
    s_add_u32 m0, s68, 118784
    s_nop 0
    buffer_load_dwordx4 v3, s[48:51], s71 offen lds
    s_add_u32 m0, s68, 119808
    s_nop 0
    buffer_load_dwordx4 v4, s[48:51], s71 offen lds
    s_add_u32 s26, s26, 1
    s_cmp_eq_u32 s26, 10
    s_cselect_b32 s26, 0, s26
L_kf_kernel_g32:
    v_mfma_f32_32x32x16_bf16 v[24:39], v[176:179], v[96:99], v[24:39]
    ds_read_b128 v[84:87], v8
    v_mfma_f32_32x32x16_bf16 v[40:55], v[180:183], v[96:99], v[40:55]
    ds_read_b64_tr_b16 v[140:141], v9 offset:9216
    ds_read_b64_tr_b16 v[142:143], v9 offset:9984
    ds_read_b64_tr_b16 v[144:145], v10 offset:9216
    ds_read_b64_tr_b16 v[146:147], v10 offset:9984
    v_mfma_f32_32x32x16_bf16 v[56:71], v[184:187], v[96:99], v[56:71]
    ds_read_b64_tr_b16 v[148:149], v11 offset:9216
    ds_read_b64_tr_b16 v[150:151], v11 offset:9984
    v_mfma_f32_32x32x16_bf16 v[24:39], v[188:191], v[100:103], v[24:39]
    v_add_u32 v5, 38912, v5
    v_add_u32 v6, 38912, v6
    v_add_u32 v7, 38912, v7
    v_add_u32 v8, 38912, v8
    v_add_u32 v9, 38912, v9
    v_add_u32 v10, 38912, v10
    v_add_u32 v11, 38912, v11
    v_mfma_f32_32x32x16_bf16 v[40:55], v[192:195], v[100:103], v[40:55]
    v_mfma_f32_32x32x16_bf16 v[56:71], v[196:199], v[100:103], v[56:71]
    s_cbranch_vccnz L_kf_kernel_n2
    s_waitcnt vmcnt(0)
    v_readfirstlane_b32 s36, v15
    v_mov_b32 v15, 0
    s_and_b32 s36, s36, 15
    s_cmp_lg_u32 s36, 15
    s_cbranch_scc1 L_kf_kernel_n2
    v_mov_b32 v14, 4
    v_mov_b32 v15, 1
    s_mov_b64 exec, 1
    buffer_atomic_add v15, v14, s[60:63], 0 offen sc0
    s_mov_b64 exec, -1
L_kf_kernel_n2:
    s_waitcnt lgkmcnt(0)
    s_cmp_lg_u32 s37, 0
    s_cbranch_scc1 L_kf_kernel_cs4b
    v_mfma_f32_16x16x32_bf16 v[200:203], v[18:21], v[220:223], v[200:203]
    v_mfma_f32_16x16x32_bf16 v[204:207], v[18:21], v[224:227], v[204:207]
    v_mfma_f32_16x16x32_bf16 v[208:211], v[18:21], v[228:231], v[208:211]
    v_mfma_f32_16x16x32_bf16 v[212:215], v[18:21], v[232:235], v[212:215]
    v_mfma_f32_16x16x32_bf16 v[216:219], v[18:21], v[236:239], v[216:219]
L_kf_kernel_cs4b:
    s_cbranch_vccz L_kf_kernel_g33
    s_waitcnt vmcnt(12)
L_kf_kernel_g33:
    s_barrier
    s_cmp_lg_u32 s37, 1
    s_cbranch_scc1 L_kf_kernel_cs5a
    ds_read_b128 v[220:223], v16 offset:0
    ds_read_b128 v[224:227], v16 offset:2048
    ds_read_b128 v[228:231], v16 offset:4096
    ds_read_b128 v[232:235], v16 offset:6144
    ds_read_b128 v[236:239], v16 offset:8192
L_kf_kernel_cs5a:
    v_add_u32 v16, 38912, v16
    v_mfma_f32_16x16x32_bf16 v[240:243], v[104:107], v[252:255], v[240:243]
    ds_read_b128 v[88:91], v5
    s_cbranch_vccz L_kf_kernel_g34
    s_lshl_b32 s38, s26, 7
    s_add_u32 m0, s69, 0
    s_nop 0
    buffer_load_dwordx4 v13, s[40:43], s38 offen lds
    s_add_u32 m0, s70, 0
    s_nop 0
    buffer_load_dwordx4 v13, s[44:47], s38 offen lds
L_kf_kernel_g34:
    v_mfma_f32_16x16x32_bf16 v[244:247], v[116:119], v[252:255], v[244:247]
    ds_read_b64_tr_b16 v[152:153], v9 offset:0
    ds_read_b64_tr_b16 v[154:155], v9 offset:768
    v_mfma_f32_16x16x32_bf16 v[240:243], v[128:131], v[252:255], v[240:243]
    ds_read_b64_tr_b16 v[156:157], v10 offset:0
    ds_read_b64_tr_b16 v[158:159], v10 offset:768
    ds_read_b64_tr_b16 v[160:161], v11 offset:0
    ds_read_b64_tr_b16 v[162:163], v11 offset:768
    v_mfma_f32_16x16x32_bf16 v[244:247], v[140:143], v[252:255], v[244:247]
    ds_read_b128 v[92:95], v6
    v_mfma_f32_32x32x16_bf16 v[24:39], v[104:107], v[72:75], v[24:39]
    ds_read_b64_tr_b16 v[164:165], v9 offset:3072
    ds_read_b64_tr_b16 v[166:167], v9 offset:3840
    s_cbranch_vccz L_kf_kernel_g35
    s_mul_i32 s71, s26, 196608
    s_add_u32 m0, s68, 0
    s_nop 0
    buffer_load_dwordx4 v1, s[48:51], s71 offen lds
    s_add_u32 m0, s68, 1024
    s_nop 0
    buffer_load_dwordx4 v2, s[48:51], s71 offen lds
L_kf_kernel_g35:
    v_mfma_f32_32x32x16_bf16 v[40:55], v[108:111], v[72:75], v[40:55]
    ds_read_b64_tr_b16 v[168:169], v10 offset:3072
    ds_read_b64_tr_b16 v[170:171], v10 offset:3840
    v_mfma_f32_32x32x16_bf16 v[56:71], v[112:115], v[72:75], v[56:71]
    ds_read_b64_tr_b16 v[172:173], v11 offset:3072
    ds_read_b64_tr_b16 v[174:175], v11 offset:3840
    v_mfma_f32_32x32x16_bf16 v[24:39], v[116:119], v[76:79], v[24:39]
    ds_read_b128 v[96:99], v7
    ds_read_b64_tr_b16 v[176:177], v9 offset:6144
    ds_read_b64_tr_b16 v[178:179], v9 offset:6912
    v_mfma_f32_32x32x16_bf16 v[40:55], v[120:123], v[76:79], v[40:55]
    ds_read_b64_tr_b16 v[180:181], v10 offset:6144
    ds_read_b64_tr_b16 v[182:183], v10 offset:6912
    v_mfma_f32_32x32x16_bf16 v[56:71], v[124:127], v[76:79], v[56:71]
    ds_read_b64_tr_b16 v[184:185], v11 offset:6144
    ds_read_b64_tr_b16 v[186:187], v11 offset:6912
    s_cbranch_vccz L_kf_kernel_g36
    s_add_u32 m0, s68, 2048
    s_nop 0
    buffer_load_dwordx4 v3, s[48:51], s71 offen lds
    s_add_u32 m0, s68, 3072
    s_nop 0
    buffer_load_dwordx4 v4, s[48:51], s71 offen lds
    s_add_u32 s26, s26, 1
    s_cmp_eq_u32 s26, 10
    s_cselect_b32 s26, 0, s26
L_kf_kernel_g36:
    v_mfma_f32_32x32x16_bf16 v[24:39], v[128:131], v[80:83], v[24:39]
    ds_read_b128 v[100:103], v8
    v_mfma_f32_32x32x16_bf16 v[40:55], v[132:135], v[80:83], v[40:55]
    ds_read_b64_tr_b16 v[188:189], v9 offset:9216
    ds_read_b64_tr_b16 v[190:191], v9 offset:9984
    ds_read_b64_tr_b16 v[192:193], v10 offset:9216
    ds_read_b64_tr_b16 v[194:195], v10 offset:9984
    v_mfma_f32_32x32x16_bf16 v[56:71], v[136:139], v[80:83], v[56:71]
    ds_read_b64_tr_b16 v[196:197], v11 offset:9216
    ds_read_b64_tr_b16 v[198:199], v11 offset:9984
    v_mfma_f32_32x32x16_bf16 v[24:39], v[140:143], v[84:87], v[24:39]
    v_add_u32 v5, 38912, v5
    v_add_u32 v6, 38912, v6
    v_add_u32 v7, 38912, v7
    v_add_u32 v8, 38912, v8
    v_add_u32 v9, 38912, v9
    v_add_u32 v10, 38912, v10
    v_add_u32 v11, 38912, v11
    v_mfma_f32_32x32x16_bf16 v[40:55], v[144:147], v[84:87], v[40:55]
    v_mfma_f32_32x32x16_bf16 v[56:71], v[148:151], v[84:87], v[56:71]
    s_waitcnt lgkmcnt(0)
    s_cmp_lg_u32 s37, 1
    s_cbranch_scc1 L_kf_kernel_cs5b
    v_mfma_f32_16x16x32_bf16 v[200:203], v[18:21], v[220:223], v[200:203]
    v_mfma_f32_16x16x32_bf16 v[204:207], v[18:21], v[224:227], v[204:207]
    v_mfma_f32_16x16x32_bf16 v[208:211], v[18:21], v[228:231], v[208:211]
    v_mfma_f32_16x16x32_bf16 v[212:215], v[18:21], v[232:235], v[212:215]
    v_mfma_f32_16x16x32_bf16 v[216:219], v[18:21], v[236:239], v[216:219]
L_kf_kernel_cs5b:
    s_cbranch_vccz L_kf_kernel_g37
    s_waitcnt vmcnt(12)
L_kf_kernel_g37:
    s_barrier
    s_cmp_lg_u32 s37, 0
    s_cbranch_scc1 L_kf_kernel_cs6a
    ds_read_b128 v[220:223], v16 offset:0
    ds_read_b128 v[224:227], v16 offset:2048
    ds_read_b128 v[228:231], v16 offset:4096
    ds_read_b128 v[232:235], v16 offset:6144
    ds_read_b128 v[236:239], v16 offset:8192
L_kf_kernel_cs6a:
    v_add_u32 v16, 38912, v16
    v_mfma_f32_16x16x32_bf16 v[240:243], v[152:155], v[252:255], v[240:243]
    ds_read_b128 v[72:75], v5
    s_cbranch_vccz L_kf_kernel_g38
    s_lshl_b32 s38, s26, 7
    s_add_u32 m0, s69, 38912
    s_nop 0
    buffer_load_dwordx4 v13, s[40:43], s38 offen lds
    s_add_u32 m0, s70, 38912
    s_nop 0
    buffer_load_dwordx4 v13, s[44:47], s38 offen lds
L_kf_kernel_g38:
    v_mfma_f32_16x16x32_bf16 v[244:247], v[164:167], v[252:255], v[244:247]
    ds_read_b64_tr_b16 v[104:105], v9 offset:0
    ds_read_b64_tr_b16 v[106:107], v9 offset:768
    v_mfma_f32_16x16x32_bf16 v[240:243], v[176:179], v[252:255], v[240:243]
    ds_read_b64_tr_b16 v[108:109], v10 offset:0
    ds_read_b64_tr_b16 v[110:111], v10 offset:768
    ds_read_b64_tr_b16 v[112:113], v11 offset:0
    ds_read_b64_tr_b16 v[114:115], v11 offset:768
    v_mfma_f32_16x16x32_bf16 v[244:247], v[188:191], v[252:255], v[244:247]
    ds_read_b128 v[76:79], v6
    v_mfma_f32_32x32x16_bf16 v[24:39], v[152:155], v[88:91], v[24:39]
    ds_read_b64_tr_b16 v[116:117], v9 offset:3072
    ds_read_b64_tr_b16 v[118:119], v9 offset:3840
    s_cbranch_vccz L_kf_kernel_g39
    s_mul_i32 s71, s26, 196608
    s_add_u32 m0, s68, 38912
    s_nop 0
    buffer_load_dwordx4 v1, s[48:51], s71 offen lds
    s_add_u32 m0, s68, 39936
    s_nop 0
    buffer_load_dwordx4 v2, s[48:51], s71 offen lds
L_kf_kernel_g39:
    v_mfma_f32_32x32x16_bf16 v[40:55], v[156:159], v[88:91], v[40:55]
    ds_read_b64_tr_b16 v[120:121], v10 offset:3072
    ds_read_b64_tr_b16 v[122:123], v10 offset:3840
    v_mfma_f32_32x32x16_bf16 v[56:71], v[160:163], v[88:91], v[56:71]
    ds_read_b64_tr_b16 v[124:125], v11 offset:3072
    ds_read_b64_tr_b16 v[126:127], v11 offset:3840
    v_mfma_f32_32x32x16_bf16 v[24:39], v[164:167], v[92:95], v[24:39]
    ds_read_b128 v[80:83], v7
    ds_read_b64_tr_b16 v[128:129], v9 offset:6144
    ds_read_b64_tr_b16 v[130:131], v9 offset:6912
    v_mfma_f32_32x32x16_bf16 v[40:55], v[168:171], v[92:95], v[40:55]
    ds_read_b64_tr_b16 v[132:133], v10 offset:6144
    ds_read_b64_tr_b16 v[134:135], v10 offset:6912
    v_mfma_f32_32x32x16_bf16 v[56:71], v[172:175], v[92:95], v[56:71]
    ds_read_b64_tr_b16 v[136:137], v11 offset:6144
    ds_read_b64_tr_b16 v[138:139], v11 offset:6912
    s_cbranch_vccz L_kf_kernel_g40
    s_add_u32 m0, s68, 40960
    s_nop 0
    buffer_load_dwordx4 v3, s[48:51], s71 offen lds
    s_add_u32 m0, s68, 41984
    s_nop 0
    buffer_load_dwordx4 v4, s[48:51], s71 offen lds
    s_add_u32 s26, s26, 1
    s_cmp_eq_u32 s26, 10
    s_cselect_b32 s26, 0, s26
L_kf_kernel_g40:
    v_mfma_f32_32x32x16_bf16 v[24:39], v[176:179], v[96:99], v[24:39]
    ds_read_b128 v[84:87], v8
    v_mfma_f32_32x32x16_bf16 v[40:55], v[180:183], v[96:99], v[40:55]
    ds_read_b64_tr_b16 v[140:141], v9 offset:9216
    ds_read_b64_tr_b16 v[142:143], v9 offset:9984
    ds_read_b64_tr_b16 v[144:145], v10 offset:9216
    ds_read_b64_tr_b16 v[146:147], v10 offset:9984
    v_mfma_f32_32x32x16_bf16 v[56:71], v[184:187], v[96:99], v[56:71]
    ds_read_b64_tr_b16 v[148:149], v11 offset:9216
    ds_read_b64_tr_b16 v[150:151], v11 offset:9984
    v_mfma_f32_32x32x16_bf16 v[24:39], v[188:191], v[100:103], v[24:39]
    v_add_u32 v5, 38912, v5
    v_add_u32 v6, 38912, v6
    v_add_u32 v7, 38912, v7
    v_add_u32 v8, 38912, v8
    v_add_u32 v9, 38912, v9
    v_add_u32 v10, 38912, v10
    v_add_u32 v11, 38912, v11
    v_mfma_f32_32x32x16_bf16 v[40:55], v[192:195], v[100:103], v[40:55]
    v_mfma_f32_32x32x16_bf16 v[56:71], v[196:199], v[100:103], v[56:71]
    s_cbranch_vccnz L_kf_kernel_si6
    s_waitcnt vmcnt(0)
    v_readfirstlane_b32 s36, v15
    s_nop 0
    s_and_b32 s36, s36, 15
    s_cmp_lg_u32 s36, 15
    s_cbranch_scc1 L_kf_kernel_nb
    s_add_u32 s52, s30, 15155200
    s_addc_u32 s53, s31, 0
    s_and_b32 s53, s53, 0xffff
    s_mov_b32 s54, 360448
    s_mov_b32 s55, 0x00020000
    v_lshlrev_b32 v14, 7, v22
    v_lshrrev_b32 v15, 4, v0
    v_mul_u32_u24 v15, 22528, v15
    v_add_u32 v14, v14, v15
    v_add_u32 v14, 20480, v14
    v_mov_b32 v15, 1511506921
    s_mov_b32 s36, 0
    buffer_store_dword v15, v14, s[52:55], s36 offen sc1
    s_mov_b32 s36, 90112
    buffer_store_dword v15, v14, s[52:55], s36 offen sc1
    s_mov_b32 s36, 180224
    buffer_store_dword v15, v14, s[52:55], s36 offen sc1
    s_mov_b32 s36, 270336
    buffer_store_dword v15, v14, s[52:55], s36 offen sc1
L_kf_kernel_nb:
L_kf_kernel_si6:
    s_waitcnt lgkmcnt(0)
    s_cmp_lg_u32 s37, 0
    s_cbranch_scc1 L_kf_kernel_cs6b
    v_mfma_f32_16x16x32_bf16 v[200:203], v[18:21], v[220:223], v[200:203]
    v_mfma_f32_16x16x32_bf16 v[204:207], v[18:21], v[224:227], v[204:207]
    v_mfma_f32_16x16x32_bf16 v[208:211], v[18:21], v[228:231], v[208:211]
    v_mfma_f32_16x16x32_bf16 v[212:215], v[18:21], v[232:235], v[212:215]
    v_mfma_f32_16x16x32_bf16 v[216:219], v[18:21], v[236:239], v[216:219]
L_kf_kernel_cs6b:
    s_cbranch_vccz L_kf_kernel_g41
    s_waitcnt vmcnt(12)
L_kf_kernel_g41:
    s_barrier
    s_cmp_lg_u32 s37, 1
    s_cbranch_scc1 L_kf_kernel_cs7a
    ds_read_b128 v[220:223], v16 offset:0
    ds_read_b128 v[224:227], v16 offset:2048
    ds_read_b128 v[228:231], v16 offset:4096
    ds_read_b128 v[232:235], v16 offset:6144
    ds_read_b128 v[236:239], v16 offset:8192
L_kf_kernel_cs7a:
    v_add_u32 v16, 4294850560, v16
    v_mfma_f32_16x16x32_bf16 v[240:243], v[104:107], v[252:255], v[240:243]
    ds_read_b128 v[88:91], v5
    s_cbranch_vccnz L_kf_kernel_g42
    s_and_b32 s36, s2, 7
    s_lshr_b32 s39, s2, 3
    s_and_b32 s26, s36, 3
    s_lshl_b32 s26, s26, 3
    s_and_b32 s27, s39, 7
    s_add_u32 s26, s26, s27
    s_lshr_b32 s27, s36, 2
    s_lshl_b32 s27, s27, 2
    s_lshr_b32 s39, s39, 3
L_kf_kernel_g42:
    v_mfma_f32_16x16x32_bf16 v[244:247], v[116:119], v[252:255], v[244:247]
    ds_read_b64_tr_b16 v[152:153], v9 offset:0
    ds_read_b64_tr_b16 v[154:155], v9 offset:768
    s_cbranch_vccnz L_kf_kernel_g43
    s_add_u32 s27, s27, s39
    s_mov_b32 s40, s24
    s_and_b32 s41, s25, 0xffff
    s_mov_b32 s42, 1966080
    s_mov_b32 s43, 0x00020000
    s_add_u32 s39, s26, 0
    s_min_u32 s39, s39, 47
    s_mul_i32 s68, s27, 245760
    s_lshl_b32 s36, s39, 10
L_kf_kernel_g43:
    v_mfma_f32_16x16x32_bf16 v[240:243], v[128:131], v[252:255], v[240:243]
    ds_read_b64_tr_b16 v[156:157], v10 offset:0
    ds_read_b64_tr_b16 v[158:159], v10 offset:768
    ds_read_b64_tr_b16 v[160:161], v11 offset:0
    ds_read_b64_tr_b16 v[162:163], v11 offset:768
    v_mfma_f32_16x16x32_bf16 v[244:247], v[140:143], v[252:255], v[244:247]
    s_cbranch_vccnz L_kf_kernel_g44
    s_add_u32 s68, s68, s36
    s_mul_i32 s39, s39, 40960
    s_mul_i32 s36, s27, 160
    s_add_u32 s22, s36, s39
    s_add_u32 s39, s26, 32
    s_min_u32 s39, s39, 47
    s_mul_i32 s69, s27, 245760
    s_lshl_b32 s36, s39, 10
    s_add_u32 s69, s69, s36
    s_mul_i32 s39, s39, 40960
L_kf_kernel_g44:
    ds_read_b128 v[92:95], v6
    v_mfma_f32_32x32x16_bf16 v[24:39], v[104:107], v[72:75], v[24:39]
    ds_read_b64_tr_b16 v[164:165], v9 offset:3072
    ds_read_b64_tr_b16 v[166:167], v9 offset:3840
    v_mfma_f32_32x32x16_bf16 v[40:55], v[108:111], v[72:75], v[40:55]
    s_cbranch_vccnz L_kf_kernel_g45
    s_mul_i32 s36, s27, 160
    s_add_u32 s23, s36, s39
    v_add_u32 v1, 0, v0
    v_mul_u32_u24 v2, 6554, v1
    v_lshrrev_b32 v2, 16, v2
    v_mul_u32_u24 v3, 10, v2
    v_sub_u32 v1, v1, v3
    v_mul_u32_u24 v2, 1280, v2
    v_lshl_add_u32 v1, v1, 4, v2
L_kf_kernel_g45:
    ds_read_b64_tr_b16 v[168:169], v10 offset:3072
    ds_read_b64_tr_b16 v[170:171], v10 offset:3840
    v_mfma_f32_32x32x16_bf16 v[56:71], v[112:115], v[72:75], v[56:71]
    s_cbranch_vccnz L_kf_kernel_g46
    s_mov_b32 m0, 77824
    s_nop 0
    buffer_load_dwordx4 v1, s[40:43], s22 offen lds
    s_mov_b32 m0, 82944
    s_nop 0
    buffer_load_dwordx4 v1, s[40:43], s23 offen lds
    v_add_u32 v1, 64, v0
    v_mul_u32_u24 v2, 6554, v1
    v_lshrrev_b32 v2, 16, v2
    v_mul_u32_u24 v3, 10, v2
    v_sub_u32 v1, v1, v3
L_kf_kernel_g46:
    ds_read_b64_tr_b16 v[172:173], v11 offset:3072
    ds_read_b64_tr_b16 v[174:175], v11 offset:3840
    v_mfma_f32_32x32x16_bf16 v[24:39], v[116:119], v[76:79], v[24:39]
    ds_read_b128 v[96:99], v7
    s_cbranch_vccnz L_kf_kernel_g47
    v_mul_u32_u24 v2, 1280, v2
    v_lshl_add_u32 v1, v1, 4, v2
    s_mov_b32 m0, 78848
    s_nop 0
    buffer_load_dwordx4 v1, s[40:43], s22 offen lds
    s_mov_b32 m0, 83968
    s_nop 0
    buffer_load_dwordx4 v1, s[40:43], s23 offen lds
    v_add_u32 v1, 128, v0
    v_mul_u32_u24 v2, 6554, v1
    v_lshrrev_b32 v2, 16, v2
L_kf_kernel_g47:
    v_mfma_f32_32x32x16_bf16 v[40:55], v[120:123], v[76:79], v[40:55]
    ds_read_b64_tr_b16 v[176:177], v9 offset:6144
    ds_read_b64_tr_b16 v[178:179], v9 offset:6912
    ds_read_b64_tr_b16 v[180:181], v10 offset:6144
    ds_read_b64_tr_b16 v[182:183], v10 offset:6912
    v_mfma_f32_32x32x16_bf16 v[56:71], v[124:127], v[76:79], v[56:71]
    s_cbranch_vccnz L_kf_kernel_g48
    v_mul_u32_u24 v3, 10, v2
    v_sub_u32 v1, v1, v3
    v_mul_u32_u24 v2, 1280, v2
    v_lshl_add_u32 v1, v1, 4, v2
    s_mov_b32 m0, 79872
    s_nop 0
    buffer_load_dwordx4 v1, s[40:43], s22 offen lds
    s_mov_b32 m0, 84992
    s_nop 0
    buffer_load_dwordx4 v1, s[40:43], s23 offen lds
    v_add_u32 v1, 192, v0
L_kf_kernel_g48:
    v_mfma_f32_32x32x16_bf16 v[24:39], v[128:131], v[80:83], v[24:39]
    ds_read_b64_tr_b16 v[184:185], v11 offset:6144
    ds_read_b64_tr_b16 v[186:187], v11 offset:6912
    s_cbranch_vccnz L_kf_kernel_g49
    v_mul_u32_u24 v2, 6554, v1
    v_lshrrev_b32 v2, 16, v2
    v_mul_u32_u24 v3, 10, v2
    v_sub_u32 v1, v1, v3
    v_mul_u32_u24 v2, 1280, v2
    v_lshl_add_u32 v1, v1, 4, v2
    s_mov_b32 m0, 80896
    s_nop 0
    buffer_load_dwordx4 v1, s[40:43], s22 offen lds
    s_mov_b32 m0, 86016
    s_nop 0
    buffer_load_dwordx4 v1, s[40:43], s23 offen lds
L_kf_kernel_g49:
    v_mfma_f32_32x32x16_bf16 v[40:55], v[132:135], v[80:83], v[40:55]
    ds_read_b128 v[100:103], v8
    ds_read_b64_tr_b16 v[188:189], v9 offset:9216
    ds_read_b64_tr_b16 v[190:191], v9 offset:9984
    v_mfma_f32_32x32x16_bf16 v[56:71], v[136:139], v[80:83], v[56:71]
    s_cbranch_vccnz L_kf_kernel_g50
    v_add_u32 v1, 256, v0
    v_mul_u32_u24 v2, 6554, v1
    v_lshrrev_b32 v2, 16, v2
    v_mul_u32_u24 v3, 10, v2
    v_sub_u32 v1, v1, v3
    v_mul_u32_u24 v2, 1280, v2
    v_lshl_add_u32 v1, v1, 4, v2
    s_mov_b32 m0, 81920
    s_nop 0
    buffer_load_dwordx4 v1, s[40:43], s22 offen lds
L_kf_kernel_g50:
    ds_read_b64_tr_b16 v[192:193], v10 offset:9216
    ds_read_b64_tr_b16 v[194:195], v10 offset:9984
    v_mfma_f32_32x32x16_bf16 v[24:39], v[140:143], v[84:87], v[24:39]
    ds_read_b64_tr_b16 v[196:197], v11 offset:9216
    ds_read_b64_tr_b16 v[198:199], v11 offset:9984
    s_cbranch_vccnz L_kf_kernel_g51
    s_mov_b32 m0, 87040
    s_nop 0
    buffer_load_dwordx4 v1, s[40:43], s23 offen lds
L_kf_kernel_g51:
    v_mfma_f32_32x32x16_bf16 v[40:55], v[144:147], v[84:87], v[40:55]
    v_add_u32 v5, 4294850560, v5
    v_add_u32 v6, 4294850560, v6
    v_add_u32 v7, 4294850560, v7
    v_add_u32 v8, 4294850560, v8
    v_add_u32 v9, 4294850560, v9
    v_add_u32 v10, 4294850560, v10
    v_add_u32 v11, 4294850560, v11
    v_mfma_f32_32x32x16_bf16 v[56:71], v[148:151], v[84:87], v[56:71]
    s_waitcnt lgkmcnt(0)
    s_cmp_lg_u32 s37, 1
    s_cbranch_scc1 L_kf_kernel_cs7b
    v_mfma_f32_16x16x32_bf16 v[200:203], v[18:21], v[220:223], v[200:203]
    v_mfma_f32_16x16x32_bf16 v[204:207], v[18:21], v[224:227], v[204:207]
    v_mfma_f32_16x16x32_bf16 v[208:211], v[18:21], v[228:231], v[208:211]
    v_mfma_f32_16x16x32_bf16 v[212:215], v[18:21], v[232:235], v[212:215]
    v_mfma_f32_16x16x32_bf16 v[216:219], v[18:21], v[236:239], v[216:219]
L_kf_kernel_cs7b:
    s_cbranch_vccz L_kf_kernel_g52
    s_waitcnt vmcnt(6)
L_kf_kernel_g52:
    s_barrier
    s_cmp_lg_u32 s37, 0
    s_cbranch_scc1 L_kf_kernel_cs8a
    ds_read_b128 v[220:223], v16 offset:0
    ds_read_b128 v[224:227], v16 offset:2048
    ds_read_b128 v[228:231], v16 offset:4096
    ds_read_b128 v[232:235], v16 offset:6144
    ds_read_b128 v[236:239], v16 offset:8192
L_kf_kernel_cs8a:
    v_add_u32 v16, 38912, v16
    v_mfma_f32_16x16x32_bf16 v[240:243], v[152:155], v[252:255], v[240:243]
    ds_read_b128 v[72:75], v5
    s_cbranch_vccnz L_kf_kernel_g53
    s_mov_b32 s44, s14
    s_and_b32 s45, s15, 0xffff
    s_mov_b32 s46, 819200
    s_mov_b32 s47, 0x00020000
    s_mov_b32 s48, s16
    s_and_b32 s49, s17, 0xffff
    s_mov_b32 s50, 819200
    s_mov_b32 s51, 0x00020000
    s_add_u32 s38, s26, 0
    s_min_u32 s38, s38, 49
L_kf_kernel_g53:
    v_mfma_f32_16x16x32_bf16 v[244:247], v[164:167], v[252:255], v[244:247]
    ds_read_b64_tr_b16 v[104:105], v9 offset:0
    ds_read_b64_tr_b16 v[106:107], v9 offset:768
    ds_read_b64_tr_b16 v[108:109], v10 offset:0
    ds_read_b64_tr_b16 v[110:111], v10 offset:768
    v_mfma_f32_16x16x32_bf16 v[240:243], v[176:179], v[252:255], v[240:243]
    s_cbranch_vccnz L_kf_kernel_g54
    s_mul_hi_u32 s36, s38, 429496730
    s_mul_i32 s39, s36, 10
    s_sub_u32 s39, s38, s39
    s_mul_i32 s38, s27, 5
    s_add_u32 s36, s36, s38
    s_mul_i32 s70, s36, 40960
    s_lshl_b32 s38, s39, 12
    s_add_u32 s70, s70, s38
    s_add_u32 s70, s70, 1966080
    s_mul_i32 s36, s36, 20480
L_kf_kernel_g54:
    v_mfma_f32_16x16x32_bf16 v[244:247], v[188:191], v[252:255], v[244:247]
    ds_read_b64_tr_b16 v[112:113], v11 offset:0
    ds_read_b64_tr_b16 v[114:115], v11 offset:768
    ds_read_b128 v[76:79], v6
    v_mfma_f32_32x32x16_bf16 v[24:39], v[152:155], v[88:91], v[24:39]
    ds_read_b64_tr_b16 v[116:117], v9 offset:3072
    ds_read_b64_tr_b16 v[118:119], v9 offset:3840
    v_mfma_f32_32x32x16_bf16 v[40:55], v[156:159], v[88:91], v[40:55]
    s_cbranch_vccnz L_kf_kernel_g55
    s_lshl_b32 s39, s39, 7
    s_add_u32 s36, s36, s39
    s_add_u32 s39, s36, 10240
    s_mov_b32 m0, 88064
    s_nop 0
    buffer_load_dwordx4 v13, s[44:47], s36 offen lds
    s_mov_b32 m0, 89088
    s_nop 0
    buffer_load_dwordx4 v13, s[44:47], s39 offen lds
    s_mov_b32 m0, 90112
    s_nop 0
    buffer_load_dwordx4 v13, s[48:51], s36 offen lds
L_kf_kernel_g55:
    ds_read_b64_tr_b16 v[120:121], v10 offset:3072
    ds_read_b64_tr_b16 v[122:123], v10 offset:3840
    v_mfma_f32_32x32x16_bf16 v[56:71], v[160:163], v[88:91], v[56:71]
    ds_read_b64_tr_b16 v[124:125], v11 offset:3072
    ds_read_b64_tr_b16 v[126:127], v11 offset:3840
    v_mfma_f32_32x32x16_bf16 v[24:39], v[164:167], v[92:95], v[24:39]
    ds_read_b128 v[80:83], v7
    s_cbranch_vccnz L_kf_kernel_g56
    s_mov_b32 m0, 91136
    s_nop 0
    buffer_load_dwordx4 v13, s[48:51], s39 offen lds
    s_add_u32 s38, s26, 32
    s_min_u32 s38, s38, 49
    s_mul_hi_u32 s36, s38, 429496730
    s_mul_i32 s39, s36, 10
    s_sub_u32 s39, s38, s39
    s_mul_i32 s38, s27, 5
    s_add_u32 s36, s36, s38
    s_mul_i32 s71, s36, 40960
L_kf_kernel_g56:
    v_mfma_f32_32x32x16_bf16 v[40:55], v[168:171], v[92:95], v[40:55]
    ds_read_b64_tr_b16 v[128:129], v9 offset:6144
    ds_read_b64_tr_b16 v[130:131], v9 offset:6912
    v_mfma_f32_32x32x16_bf16 v[56:71], v[172:175], v[92:95], v[56:71]
    ds_read_b64_tr_b16 v[132:133], v10 offset:6144
    ds_read_b64_tr_b16 v[134:135], v10 offset:6912
    ds_read_b64_tr_b16 v[136:137], v11 offset:6144
    ds_read_b64_tr_b16 v[138:139], v11 offset:6912
    v_mfma_f32_32x32x16_bf16 v[24:39], v[176:179], v[96:99], v[24:39]
    s_cbranch_vccnz L_kf_kernel_g57
    s_lshl_b32 s38, s39, 12
    s_add_u32 s71, s71, s38
    s_add_u32 s71, s71, 1966080
    s_mul_i32 s36, s36, 20480
    s_lshl_b32 s39, s39, 7
    s_add_u32 s36, s36, s39
    s_add_u32 s39, s36, 10240
    s_mov_b32 m0, 92160
    s_nop 0
    buffer_load_dwordx4 v13, s[44:47], s36 offen lds
L_kf_kernel_g57:
    v_mfma_f32_32x32x16_bf16 v[40:55], v[180:183], v[96:99], v[40:55]
    ds_read_b128 v[84:87], v8
    ds_read_b64_tr_b16 v[140:141], v9 offset:9216
    ds_read_b64_tr_b16 v[142:143], v9 offset:9984
    v_mfma_f32_32x32x16_bf16 v[56:71], v[184:187], v[96:99], v[56:71]
    ds_read_b64_tr_b16 v[144:145], v10 offset:9216
    ds_read_b64_tr_b16 v[146:147], v10 offset:9984
    v_mfma_f32_32x32x16_bf16 v[24:39], v[188:191], v[100:103], v[24:39]
    s_cbranch_vccnz L_kf_kernel_g58
    s_mov_b32 m0, 93184
    s_nop 0
    buffer_load_dwordx4 v13, s[44:47], s39 offen lds
    s_mov_b32 m0, 94208
    s_nop 0
    buffer_load_dwordx4 v13, s[48:51], s36 offen lds
    s_mov_b32 m0, 95232
    s_nop 0
    buffer_load_dwordx4 v13, s[48:51], s39 offen lds
L_kf_kernel_g58:
    ds_read_b64_tr_b16 v[148:149], v11 offset:9216
    ds_read_b64_tr_b16 v[150:151], v11 offset:9984
    v_mfma_f32_32x32x16_bf16 v[40:55], v[192:195], v[100:103], v[40:55]
    v_add_u32 v5, 38912, v5
    v_add_u32 v6, 38912, v6
    v_add_u32 v7, 38912, v7
    v_add_u32 v8, 38912, v8
    v_add_u32 v9, 38912, v9
    v_add_u32 v10, 38912, v10
    v_add_u32 v11, 38912, v11
    v_mfma_f32_32x32x16_bf16 v[56:71], v[196:199], v[100:103], v[56:71]
    s_waitcnt lgkmcnt(0)
    s_cmp_lg_u32 s37, 0
    s_cbranch_scc1 L_kf_kernel_cs8b
    v_mfma_f32_16x16x32_bf16 v[200:203], v[18:21], v[220:223], v[200:203]
    v_mfma_f32_16x16x32_bf16 v[204:207], v[18:21], v[224:227], v[204:207]
    v_mfma_f32_16x16x32_bf16 v[208:211], v[18:21], v[228:231], v[208:211]
    v_mfma_f32_16x16x32_bf16 v[212:215], v[18:21], v[232:235], v[212:215]
    v_mfma_f32_16x16x32_bf16 v[216:219], v[18:21], v[236:239], v[216:219]
L_kf_kernel_cs8b:
    s_cbranch_vccz L_kf_kernel_g59
    s_waitcnt vmcnt(0)
L_kf_kernel_g59:
    s_barrier
    s_cmp_lg_u32 s37, 1
    s_cbranch_scc1 L_kf_kernel_cs9a
    ds_read_b128 v[220:223], v16 offset:0
    ds_read_b128 v[224:227], v16 offset:2048
    ds_read_b128 v[228:231], v16 offset:4096
    ds_read_b128 v[232:235], v16 offset:6144
    ds_read_b128 v[236:239], v16 offset:8192
L_kf_kernel_cs9a:
    v_add_u32 v16, 38912, v16
    v_mfma_f32_16x16x32_bf16 v[240:243], v[104:107], v[252:255], v[240:243]
    v_mfma_f32_16x16x32_bf16 v[244:247], v[116:119], v[252:255], v[244:247]
    v_mfma_f32_16x16x32_bf16 v[240:243], v[128:131], v[252:255], v[240:243]
    v_mfma_f32_16x16x32_bf16 v[244:247], v[140:143], v[252:255], v[244:247]
    v_mfma_f32_32x32x16_bf16 v[24:39], v[104:107], v[72:75], v[24:39]
    v_mfma_f32_32x32x16_bf16 v[40:55], v[108:111], v[72:75], v[40:55]
    s_waitcnt lgkmcnt(0)
    s_cmp_lg_u32 s37, 1
    s_cbranch_scc1 L_kf_kernel_cs9b
    v_mfma_f32_16x16x32_bf16 v[200:203], v[18:21], v[220:223], v[200:203]
    v_mfma_f32_16x16x32_bf16 v[204:207], v[18:21], v[224:227], v[204:207]
    v_mfma_f32_16x16x32_bf16 v[208:211], v[18:21], v[228:231], v[208:211]
    v_mfma_f32_16x16x32_bf16 v[212:215], v[18:21], v[232:235], v[212:215]
    v_mfma_f32_16x16x32_bf16 v[216:219], v[18:21], v[236:239], v[216:219]
L_kf_kernel_cs9b:
    v_mfma_f32_32x32x16_bf16 v[56:71], v[112:115], v[72:75], v[56:71]
    v_mfma_f32_32x32x16_bf16 v[24:39], v[116:119], v[76:79], v[24:39]
    s_mul_i32 s36, s35, 320
    s_add_u32 s36, s36, 162304
    v_lshlrev_b32 v17, 2, v22
    v_add_u32 v17, s36, v17
    s_nop 3
    s_mov_b64 exec, 0xffff
    ds_write_b32 v17, v200 offset:0
    ds_write_b32 v17, v204 offset:64
    ds_write_b32 v17, v208 offset:128
    ds_write_b32 v17, v212 offset:192
    ds_write_b32 v17, v216 offset:256
    v_mov_b32 v16, 161156
    v_mov_b32 v17, 1
    s_mov_b64 exec, 1
    ds_add_u32 v16, v17
    s_mov_b64 exec, -1
    v_mfma_f32_32x32x16_bf16 v[40:55], v[120:123], v[76:79], v[40:55]
    ds_read_b128 v[88:91], v5
    ds_read_b64_tr_b16 v[152:153], v9 offset:0
    ds_read_b64_tr_b16 v[154:155], v9 offset:768
    ds_read_b64_tr_b16 v[156:157], v10 offset:0
    ds_read_b64_tr_b16 v[158:159], v10 offset:768
    v_mfma_f32_32x32x16_bf16 v[56:71], v[124:127], v[76:79], v[56:71]
    ds_read_b64_tr_b16 v[160:161], v11 offset:0
    ds_read_b64_tr_b16 v[162:163], v11 offset:768
    ds_read_b128 v[92:95], v6
    v_mfma_f32_32x32x16_bf16 v[24:39], v[128:131], v[80:83], v[24:39]
    ds_read_b64_tr_b16 v[164:165], v9 offset:3072
    ds_read_b64_tr_b16 v[166:167], v9 offset:3840
    ds_read_b64_tr_b16 v[168:169], v10 offset:3072
    ds_read_b64_tr_b16 v[170:171], v10 offset:3840
    ds_read_b64_tr_b16 v[172:173], v11 offset:3072
    ds_read_b64_tr_b16 v[174:175], v11 offset:3840
    v_mfma_f32_32x32x16_bf16 v[40:55], v[132:135], v[80:83], v[40:55]
    ds_read_b128 v[96:99], v7
    ds_read_b64_tr_b16 v[176:177], v9 offset:6144
    ds_read_b64_tr_b16 v[178:179], v9 offset:6912
    v_mfma_f32_32x32x16_bf16 v[56:71], v[136:139], v[80:83], v[56:71]
    ds_read_b64_tr_b16 v[180:181], v10 offset:6144
    ds_read_b64_tr_b16 v[182:183], v10 offset:6912
    ds_read_b64_tr_b16 v[184:185], v11 offset:6144
    ds_read_b64_tr_b16 v[186:187], v11 offset:6912
    ds_read_b128 v[100:103], v8
    v_mfma_f32_32x32x16_bf16 v[24:39], v[140:143], v[84:87], v[24:39]
    ds_read_b64_tr_b16 v[188:189], v9 offset:9216
    ds_read_b64_tr_b16 v[190:191], v9 offset:9984
    ds_read_b64_tr_b16 v[192:193], v10 offset:9216
    ds_read_b64_tr_b16 v[194:195], v10 offset:9984
    v_mfma_f32_32x32x16_bf16 v[40:55], v[144:147], v[84:87], v[40:55]
    ds_read_b64_tr_b16 v[196:197], v11 offset:9216
    ds_read_b64_tr_b16 v[198:199], v11 offset:9984
    v_add_u32 v5, 38912, v5
    v_add_u32 v6, 38912, v6
    v_add_u32 v7, 38912, v7
    v_add_u32 v8, 38912, v8
    v_add_u32 v9, 38912, v9
    v_add_u32 v10, 38912, v10
    v_add_u32 v11, 38912, v11
    v_mfma_f32_32x32x16_bf16 v[56:71], v[148:151], v[84:87], v[56:71]
    s_cbranch_vccnz L_kf_kernel_nb1
    v_min_u32 v17, 47, v0
    v_lshlrev_b32 v17, 3, v17
    v_add_u32 v17, 34816, v17
    v_lshlrev_b32 v2, 16, v4
    v_and_b32 v3, 0xffff0000, v4
    ds_write_b64 v17, v[2:3]
L_kf_kernel_nb1:
    s_waitcnt lgkmcnt(0)
    s_lshl_b32 s38, s35, 2
    s_add_u32 s38, s38, 161168
    v_mfma_f32_16x16x32_bf16 v[240:243], v[152:155], v[252:255], v[240:243]
    v_mfma_f32_16x16x32_bf16 v[244:247], v[164:167], v[252:255], v[244:247]
    v_mfma_f32_16x16x32_bf16 v[240:243], v[176:179], v[252:255], v[240:243]
    v_mfma_f32_16x16x32_bf16 v[244:247], v[188:191], v[252:255], v[244:247]
    v_mfma_f32_32x32x16_bf16 v[24:39], v[152:155], v[88:91], v[24:39]
    v_mfma_f32_32x32x16_bf16 v[40:55], v[156:159], v[88:91], v[40:55]
    v_mfma_f32_32x32x16_bf16 v[56:71], v[160:163], v[88:91], v[56:71]
    v_mfma_f32_32x32x16_bf16 v[24:39], v[164:167], v[92:95], v[24:39]
    s_nop 3
    v_add_f32 v240, v240, v244
    v_add_f32 v241, v241, v245
    v_add_f32 v242, v242, v246
    v_add_f32 v243, v243, v247
    v_and_b32 v16, 1, v0
    v_lshlrev_b32 v16, 6, v16
    v_lshrrev_b32 v17, 4, v0
    v_lshl_add_u32 v16, v17, 4, v16
    s_lshl_b32 s36, s4, 7
    s_add_u32 s36, s36, 160768
    v_add_u32 v16, s36, v16
    s_mov_b32 exec_lo, 0x00030003
    s_mov_b32 exec_hi, 0x00030003
    ds_write_b128 v16, v[240:243]
    v_mov_b32 v16, 161160
    v_mov_b32 v17, 1
    s_mov_b64 exec, 1
    ds_add_u32 v16, v17
    s_mov_b64 exec, -1
    v_mfma_f32_32x32x16_bf16 v[40:55], v[168:171], v[92:95], v[40:55]
    v_mfma_f32_32x32x16_bf16 v[56:71], v[172:175], v[92:95], v[56:71]
    v_mfma_f32_32x32x16_bf16 v[24:39], v[176:179], v[96:99], v[24:39]
    v_mfma_f32_32x32x16_bf16 v[40:55], v[180:183], v[96:99], v[40:55]
    v_mfma_f32_32x32x16_bf16 v[56:71], v[184:187], v[96:99], v[56:71]
    v_mfma_f32_32x32x16_bf16 v[24:39], v[188:191], v[100:103], v[24:39]
    v_mfma_f32_32x32x16_bf16 v[40:55], v[192:195], v[100:103], v[40:55]
    v_mfma_f32_32x32x16_bf16 v[56:71], v[196:199], v[100:103], v[56:71]
    s_cbranch_vccnz L_kf_kernel_sjl
    s_waitcnt vmcnt(0)
    s_add_u32 s40, s30, 11534336
    s_addc_u32 s41, s31, 0
    s_and_b32 s41, s41, 0xffff
    s_mov_b32 s42, 3604480
    s_mov_b32 s43, 0x00020000
    v_lshrrev_b32 v1, 4, v0
    v_lshrrev_b32 v2, 1, v1
    v_lshlrev_b32 v12, 4, v2
    v_and_b32 v3, 1, v1
    v_lshl_add_u32 v12, v3, 2, v12
    v_lshrrev_b32 v17, 2, v22
    v_add_u32 v12, v12, v17
    v_mul_u32_u24 v12, 160, v12
    v_and_b32 v17, 3, v22
    v_lshl_add_u32 v12, v17, 3, v12
    v_add_u32 v12, 77824, v12
    v_lshlrev_b32 v3, 11, v3
    v_lshl_add_u32 v3, v22, 7, v3
    v_and_b32 v17, 7, v22
    v_xor_b32 v2, v2, v17
    v_lshl_add_u32 v3, v2, 4, v3
    v_add_u32 v3, 88064, v3
    v_lshlrev_b32 v1, 4, v0
    ds_read_b64_tr_b16 v[104:105], v12 offset:0
    ds_read_b64_tr_b16 v[106:107], v12 offset:1280
    ds_read_b64_tr_b16 v[108:109], v12 offset:32
    ds_read_b64_tr_b16 v[110:111], v12 offset:1312
    ds_read_b64_tr_b16 v[112:113], v12 offset:64
    ds_read_b64_tr_b16 v[114:115], v12 offset:1344
    ds_read_b64_tr_b16 v[116:117], v12 offset:96
    ds_read_b64_tr_b16 v[118:119], v12 offset:1376
    ds_read_b64_tr_b16 v[120:121], v12 offset:128
    ds_read_b64_tr_b16 v[122:123], v12 offset:1408
    ds_read_b64_tr_b16 v[124:125], v12 offset:5120
    ds_read_b64_tr_b16 v[126:127], v12 offset:6400
    ds_read_b64_tr_b16 v[128:129], v12 offset:5152
    ds_read_b64_tr_b16 v[130:131], v12 offset:6432
    ds_read_b64_tr_b16 v[132:133], v12 offset:5184
    ds_read_b64_tr_b16 v[134:135], v12 offset:6464
    ds_read_b64_tr_b16 v[136:137], v12 offset:5216
    ds_read_b64_tr_b16 v[138:139], v12 offset:6496
    ds_read_b64_tr_b16 v[140:141], v12 offset:5248
    ds_read_b64_tr_b16 v[142:143], v12 offset:6528
    v_xor_b32 v2, 0, v3
    ds_read_b128 v[220:223], v2 offset:0
    ds_read_b128 v[200:203], v2 offset:4096
    v_xor_b32 v2, 32, v3
    ds_read_b128 v[224:227], v2 offset:0
    ds_read_b128 v[204:207], v2 offset:4096
    v_xor_b32 v2, 64, v3
    ds_read_b128 v[228:231], v2 offset:0
    ds_read_b128 v[208:211], v2 offset:4096
    v_xor_b32 v2, 96, v3
    ds_read_b128 v[232:235], v2 offset:0
    ds_read_b128 v[212:215], v2 offset:4096
    s_waitcnt lgkmcnt(0)
    buffer_store_dwordx4 v[104:107], v1, s[40:43], s68 offen sc1
    s_add_u32 s68, s68, 49152
    buffer_store_dwordx4 v[108:111], v1, s[40:43], s68 offen sc1
    s_add_u32 s68, s68, 49152
    buffer_store_dwordx4 v[112:115], v1, s[40:43], s68 offen sc1
    s_add_u32 s68, s68, 49152
    buffer_store_dwordx4 v[116:119], v1, s[40:43], s68 offen sc1
    s_add_u32 s68, s68, 49152
    buffer_store_dwordx4 v[120:123], v1, s[40:43], s68 offen sc1
    buffer_store_dwordx4 v[124:127], v1, s[40:43], s69 offen sc1
    s_add_u32 s69, s69, 49152
    buffer_store_dwordx4 v[128:131], v1, s[40:43], s69 offen sc1
    s_add_u32 s69, s69, 49152
    buffer_store_dwordx4 v[132:135], v1, s[40:43], s69 offen sc1
    s_add_u32 s69, s69, 49152
    buffer_store_dwordx4 v[136:139], v1, s[40:43], s69 offen sc1
    s_add_u32 s69, s69, 49152
    buffer_store_dwordx4 v[140:143], v1, s[40:43], s69 offen sc1
    buffer_store_dwordx4 v[220:223], v1, s[40:43], s70 offen offset:0 sc1
    buffer_store_dwordx4 v[224:227], v1, s[40:43], s70 offen offset:1024 sc1
    buffer_store_dwordx4 v[228:231], v1, s[40:43], s70 offen offset:2048 sc1
    buffer_store_dwordx4 v[232:235], v1, s[40:43], s70 offen offset:3072 sc1
    buffer_store_dwordx4 v[200:203], v1, s[40:43], s71 offen offset:0 sc1
    buffer_store_dwordx4 v[204:207], v1, s[40:43], s71 offen offset:1024 sc1
    buffer_store_dwordx4 v[208:211], v1, s[40:43], s71 offen offset:2048 sc1
    buffer_store_dwordx4 v[212:215], v1, s[40:43], s71 offen offset:3072 sc1
    v_mov_b32 v1, 161192
    v_mov_b32 v2, 1
    s_mov_b64 exec, 1
    ds_add_u32 v1, v2
    s_mov_b64 exec, -1
L_kf_kernel_sjl:
    v_mov_b32 v16, 161160
    s_mov_b32 s39, 0
L_kf_kernel_mw1:
    ds_read_b32 v17, v16
    s_waitcnt lgkmcnt(0)
    v_readfirstlane_b32 s36, v17
    s_add_u32 s39, s39, 1
    s_cmp_eq_u32 s36, 4
    s_cbranch_scc1 L_kf_kernel_mw1d
    s_sleep 1
    s_cmp_lt_u32 s39, 0x400000
    s_cbranch_scc1 L_kf_kernel_mw1
L_kf_kernel_mw1d:
    v_mov_b32 v16, s38
    s_mov_b32 s39, 0
L_kf_kernel_mw2:
    ds_read_b32 v17, v16
    s_waitcnt lgkmcnt(0)
    v_readfirstlane_b32 s36, v17
    s_add_u32 s39, s39, 1
    s_cmp_eq_u32 s36, 1
    s_cbranch_scc1 L_kf_kernel_mw2d
    s_sleep 1
    s_cmp_lt_u32 s39, 0x400000
    s_cbranch_scc1 L_kf_kernel_mw2
L_kf_kernel_mw2d:
    s_lshl_b32 s36, s32, 7
    s_add_u32 s36, s36, 20480
    v_mov_b32 v7, s36
    buffer_load_dword v7, v7, s[64:67], 0 offen sc1
    s_setprio 3
    v_lshrrev_b32 v10, 5, v0
    v_lshlrev_b32 v11, 4, v10
    v_add_u32 v12, 34816, v11
    v_add_u32 v11, 160768, v11
    v_lshrrev_b32 v23, 1, v23
    v_add_u32 v23, 161280, v23
    ds_read_b32 v14, v23
    ds_read_b32 v15, v23 offset:512
    s_lshl_b32 s36, s4, 7
    v_add_u32 v16, s36, v11
    v_add_u32 v17, s36, v12
    s_lshl_b32 s4, s4, 10
    ds_read_b128 v[72:75], v16 offset:0
    ds_read_b128 v[120:123], v17 offset:0
    ds_read_b128 v[76:79], v16 offset:32
    ds_read_b128 v[124:127], v17 offset:32
    ds_read_b128 v[80:83], v16 offset:64
    ds_read_b128 v[128:131], v17 offset:64
    ds_read_b128 v[84:87], v16 offset:96
    ds_read_b128 v[132:135], v17 offset:96
    s_lshl_b32 s36, s5, 7
    v_add_u32 v16, s36, v11
    v_add_u32 v17, s36, v12
    s_lshl_b32 s5, s5, 10
    ds_read_b128 v[88:91], v16 offset:0
    ds_read_b128 v[136:139], v17 offset:0
    ds_read_b128 v[92:95], v16 offset:32
    ds_read_b128 v[140:143], v17 offset:32
    ds_read_b128 v[96:99], v16 offset:64
    ds_read_b128 v[144:147], v17 offset:64
    ds_read_b128 v[100:103], v16 offset:96
    ds_read_b128 v[148:151], v17 offset:96
    s_lshl_b32 s36, s6, 7
    v_add_u32 v16, s36, v11
    v_add_u32 v17, s36, v12
    s_lshl_b32 s6, s6, 10
    ds_read_b128 v[104:107], v16 offset:0
    ds_read_b128 v[152:155], v17 offset:0
    ds_read_b128 v[108:111], v16 offset:32
    ds_read_b128 v[156:159], v17 offset:32
    ds_read_b128 v[112:115], v16 offset:64
    ds_read_b128 v[160:163], v17 offset:64
    ds_read_b128 v[116:119], v16 offset:96
    ds_read_b128 v[164:167], v17 offset:96
    s_lshl_b32 s36, s32, 2
    s_add_u32 s36, s36, s35
    s_mul_i32 s36, s36, 98304
    s_mul_i32 s39, s33, 3072
    s_add_u32 s36, s36, s39
    s_add_u32 s56, s30, s36
    s_addc_u32 s57, s31, 0
    s_and_b32 s57, s57, 0xffff
    s_mov_b32 s58, 52224
    s_mov_b32 s59, 0x00020000
    v_bfe_u32 v9, v0, 4, 1
    v_mul_u32_u24 v9, 49152, v9
    v_lshl_add_u32 v9, v10, 8, v9
    v_lshl_add_u32 v9, v22, 4, v9
    v_mov_b32 v16, 3184710632
    v_mov_b32 v17, 3222493025
    s_waitcnt lgkmcnt(15)
    v_pk_fma_f32 v[120:121], v[14:15], v[72:73], v[120:121] op_sel:[0,0,0] op_sel_hi:[0,1,1] neg_lo:[1,0,0] neg_hi:[1,0,0]
    v_pk_fma_f32 v[122:123], v[14:15], v[74:75], v[122:123] op_sel:[0,0,0] op_sel_hi:[0,1,1] neg_lo:[1,0,0] neg_hi:[1,0,0]
    v_pk_fma_f32 v[124:125], v[14:15], v[76:77], v[124:125] op_sel:[0,0,0] op_sel_hi:[0,1,1] neg_lo:[1,0,0] neg_hi:[1,0,0]
    v_pk_fma_f32 v[126:127], v[14:15], v[78:79], v[126:127] op_sel:[0,0,0] op_sel_hi:[0,1,1] neg_lo:[1,0,0] neg_hi:[1,0,0]
    v_pk_fma_f32 v[128:129], v[14:15], v[80:81], v[128:129] op_sel:[0,0,0] op_sel_hi:[0,1,1] neg_lo:[1,0,0] neg_hi:[1,0,0]
    v_pk_fma_f32 v[130:131], v[14:15], v[82:83], v[130:131] op_sel:[0,0,0] op_sel_hi:[0,1,1] neg_lo:[1,0,0] neg_hi:[1,0,0]
    v_pk_fma_f32 v[132:133], v[14:15], v[84:85], v[132:133] op_sel:[0,0,0] op_sel_hi:[0,1,1] neg_lo:[1,0,0] neg_hi:[1,0,0]
    v_pk_fma_f32 v[134:135], v[14:15], v[86:87], v[134:135] op_sel:[0,0,0] op_sel_hi:[0,1,1] neg_lo:[1,0,0] neg_hi:[1,0,0]
    v_pk_fma_f32 v[24:25], v[24:25], v[14:15], v[120:121] op_sel:[0,1,0] op_sel_hi:[1,1,1]
    v_pk_fma_f32 v[26:27], v[26:27], v[14:15], v[122:123] op_sel:[0,1,0] op_sel_hi:[1,1,1]
    v_pk_fma_f32 v[28:29], v[28:29], v[14:15], v[124:125] op_sel:[0,1,0] op_sel_hi:[1,1,1]
    v_pk_fma_f32 v[30:31], v[30:31], v[14:15], v[126:127] op_sel:[0,1,0] op_sel_hi:[1,1,1]
    v_pk_fma_f32 v[32:33], v[32:33], v[14:15], v[128:129] op_sel:[0,1,0] op_sel_hi:[1,1,1]
    v_pk_fma_f32 v[34:35], v[34:35], v[14:15], v[130:131] op_sel:[0,1,0] op_sel_hi:[1,1,1]
    v_pk_fma_f32 v[36:37], v[36:37], v[14:15], v[132:133] op_sel:[0,1,0] op_sel_hi:[1,1,1]
    v_pk_fma_f32 v[38:39], v[38:39], v[14:15], v[134:135] op_sel:[0,1,0] op_sel_hi:[1,1,1]
    v_pk_mul_f32 v[200:201], v[24:25], v[24:25]
    v_pk_mul_f32 v[202:203], v[26:27], v[26:27]
    v_pk_mul_f32 v[204:205], v[28:29], v[28:29]
    v_pk_mul_f32 v[206:207], v[30:31], v[30:31]
    v_pk_mul_f32 v[208:209], v[32:33], v[32:33]
    v_pk_mul_f32 v[210:211], v[34:35], v[34:35]
    v_pk_mul_f32 v[212:213], v[36:37], v[36:37]
    v_pk_mul_f32 v[214:215], v[38:39], v[38:39]
    v_pk_fma_f32 v[200:201], v[200:201], v[16:17], v[16:17] op_sel:[0,0,1] op_sel_hi:[1,0,1]
    v_pk_fma_f32 v[202:203], v[202:203], v[16:17], v[16:17] op_sel:[0,0,1] op_sel_hi:[1,0,1]
    v_pk_fma_f32 v[204:205], v[204:205], v[16:17], v[16:17] op_sel:[0,0,1] op_sel_hi:[1,0,1]
    v_pk_fma_f32 v[206:207], v[206:207], v[16:17], v[16:17] op_sel:[0,0,1] op_sel_hi:[1,0,1]
    v_pk_fma_f32 v[208:209], v[208:209], v[16:17], v[16:17] op_sel:[0,0,1] op_sel_hi:[1,0,1]
    v_pk_fma_f32 v[210:211], v[210:211], v[16:17], v[16:17] op_sel:[0,0,1] op_sel_hi:[1,0,1]
    v_pk_fma_f32 v[212:213], v[212:213], v[16:17], v[16:17] op_sel:[0,0,1] op_sel_hi:[1,0,1]
    v_pk_fma_f32 v[214:215], v[214:215], v[16:17], v[16:17] op_sel:[0,0,1] op_sel_hi:[1,0,1]
    v_pk_mul_f32 v[200:201], v[200:201], v[24:25]
    v_pk_mul_f32 v[202:203], v[202:203], v[26:27]
    v_pk_mul_f32 v[204:205], v[204:205], v[28:29]
    v_pk_mul_f32 v[206:207], v[206:207], v[30:31]
    v_pk_mul_f32 v[208:209], v[208:209], v[32:33]
    v_pk_mul_f32 v[210:211], v[210:211], v[34:35]
    v_pk_mul_f32 v[212:213], v[212:213], v[36:37]
    v_pk_mul_f32 v[214:215], v[214:215], v[38:39]
    v_exp_f32 v200, v200
    v_exp_f32 v201, v201
    v_exp_f32 v202, v202
    v_exp_f32 v203, v203
    v_exp_f32 v204, v204
    v_exp_f32 v205, v205
    v_exp_f32 v206, v206
    v_exp_f32 v207, v207
    v_exp_f32 v208, v208
    v_exp_f32 v209, v209
    v_exp_f32 v210, v210
    v_exp_f32 v211, v211
    v_exp_f32 v212, v212
    v_exp_f32 v213, v213
    v_exp_f32 v214, v214
    v_exp_f32 v215, v215
    v_pk_add_f32 v[200:201], v[200:201], 1.0 op_sel_hi:[1,0]
    v_pk_add_f32 v[202:203], v[202:203], 1.0 op_sel_hi:[1,0]
    v_pk_add_f32 v[204:205], v[204:205], 1.0 op_sel_hi:[1,0]
    v_pk_add_f32 v[206:207], v[206:207], 1.0 op_sel_hi:[1,0]
    v_pk_add_f32 v[208:209], v[208:209], 1.0 op_sel_hi:[1,0]
    v_pk_add_f32 v[210:211], v[210:211], 1.0 op_sel_hi:[1,0]
    v_pk_add_f32 v[212:213], v[212:213], 1.0 op_sel_hi:[1,0]
    v_pk_add_f32 v[214:215], v[214:215], 1.0 op_sel_hi:[1,0]
    v_rcp_f32 v200, v200
    v_rcp_f32 v201, v201
    v_rcp_f32 v202, v202
    v_rcp_f32 v203, v203
    v_rcp_f32 v204, v204
    v_rcp_f32 v205, v205
    v_rcp_f32 v206, v206
    v_rcp_f32 v207, v207
    v_rcp_f32 v208, v208
    v_rcp_f32 v209, v209
    v_rcp_f32 v210, v210
    v_rcp_f32 v211, v211
    v_rcp_f32 v212, v212
    v_rcp_f32 v213, v213
    v_rcp_f32 v214, v214
    v_rcp_f32 v215, v215
    v_pk_mul_f32 v[24:25], v[24:25], v[200:201]
    v_pk_mul_f32 v[26:27], v[26:27], v[202:203]
    v_pk_mul_f32 v[28:29], v[28:29], v[204:205]
    v_pk_mul_f32 v[30:31], v[30:31], v[206:207]
    v_pk_mul_f32 v[32:33], v[32:33], v[208:209]
    v_pk_mul_f32 v[34:35], v[34:35], v[210:211]
    v_pk_mul_f32 v[36:37], v[36:37], v[212:213]
    v_pk_mul_f32 v[38:39], v[38:39], v[214:215]
    v_cvt_pk_bf16_f32 v216, v24, v25
    v_cvt_pk_bf16_f32 v217, v26, v27
    v_cvt_pk_bf16_f32 v218, v28, v29
    v_cvt_pk_bf16_f32 v219, v30, v31
    v_cvt_pk_bf16_f32 v220, v32, v33
    v_cvt_pk_bf16_f32 v221, v34, v35
    v_cvt_pk_bf16_f32 v222, v36, v37
    v_cvt_pk_bf16_f32 v223, v38, v39
    buffer_store_dwordx4 v[216:219], v9, s[56:59], s4 offen offset:0 sc1
    buffer_store_dwordx4 v[220:223], v9, s[56:59], s4 offen offset:512 sc1
    s_waitcnt lgkmcnt(8)
    v_pk_fma_f32 v[136:137], v[14:15], v[88:89], v[136:137] op_sel:[0,0,0] op_sel_hi:[0,1,1] neg_lo:[1,0,0] neg_hi:[1,0,0]
    v_pk_fma_f32 v[138:139], v[14:15], v[90:91], v[138:139] op_sel:[0,0,0] op_sel_hi:[0,1,1] neg_lo:[1,0,0] neg_hi:[1,0,0]
    v_pk_fma_f32 v[140:141], v[14:15], v[92:93], v[140:141] op_sel:[0,0,0] op_sel_hi:[0,1,1] neg_lo:[1,0,0] neg_hi:[1,0,0]
    v_pk_fma_f32 v[142:143], v[14:15], v[94:95], v[142:143] op_sel:[0,0,0] op_sel_hi:[0,1,1] neg_lo:[1,0,0] neg_hi:[1,0,0]
    v_pk_fma_f32 v[144:145], v[14:15], v[96:97], v[144:145] op_sel:[0,0,0] op_sel_hi:[0,1,1] neg_lo:[1,0,0] neg_hi:[1,0,0]
    v_pk_fma_f32 v[146:147], v[14:15], v[98:99], v[146:147] op_sel:[0,0,0] op_sel_hi:[0,1,1] neg_lo:[1,0,0] neg_hi:[1,0,0]
    v_pk_fma_f32 v[148:149], v[14:15], v[100:101], v[148:149] op_sel:[0,0,0] op_sel_hi:[0,1,1] neg_lo:[1,0,0] neg_hi:[1,0,0]
    v_pk_fma_f32 v[150:151], v[14:15], v[102:103], v[150:151] op_sel:[0,0,0] op_sel_hi:[0,1,1] neg_lo:[1,0,0] neg_hi:[1,0,0]
    v_pk_fma_f32 v[40:41], v[40:41], v[14:15], v[136:137] op_sel:[0,1,0] op_sel_hi:[1,1,1]
    v_pk_fma_f32 v[42:43], v[42:43], v[14:15], v[138:139] op_sel:[0,1,0] op_sel_hi:[1,1,1]
    v_pk_fma_f32 v[44:45], v[44:45], v[14:15], v[140:141] op_sel:[0,1,0] op_sel_hi:[1,1,1]
    v_pk_fma_f32 v[46:47], v[46:47], v[14:15], v[142:143] op_sel:[0,1,0] op_sel_hi:[1,1,1]
    v_pk_fma_f32 v[48:49], v[48:49], v[14:15], v[144:145] op_sel:[0,1,0] op_sel_hi:[1,1,1]
    v_pk_fma_f32 v[50:51], v[50:51], v[14:15], v[146:147] op_sel:[0,1,0] op_sel_hi:[1,1,1]
    v_pk_fma_f32 v[52:53], v[52:53], v[14:15], v[148:149] op_sel:[0,1,0] op_sel_hi:[1,1,1]
    v_pk_fma_f32 v[54:55], v[54:55], v[14:15], v[150:151] op_sel:[0,1,0] op_sel_hi:[1,1,1]
    v_pk_mul_f32 v[200:201], v[40:41], v[40:41]
    v_pk_mul_f32 v[202:203], v[42:43], v[42:43]
    v_pk_mul_f32 v[204:205], v[44:45], v[44:45]
    v_pk_mul_f32 v[206:207], v[46:47], v[46:47]
    v_pk_mul_f32 v[208:209], v[48:49], v[48:49]
    v_pk_mul_f32 v[210:211], v[50:51], v[50:51]
    v_pk_mul_f32 v[212:213], v[52:53], v[52:53]
    v_pk_mul_f32 v[214:215], v[54:55], v[54:55]
    v_pk_fma_f32 v[200:201], v[200:201], v[16:17], v[16:17] op_sel:[0,0,1] op_sel_hi:[1,0,1]
    v_pk_fma_f32 v[202:203], v[202:203], v[16:17], v[16:17] op_sel:[0,0,1] op_sel_hi:[1,0,1]
    v_pk_fma_f32 v[204:205], v[204:205], v[16:17], v[16:17] op_sel:[0,0,1] op_sel_hi:[1,0,1]
    v_pk_fma_f32 v[206:207], v[206:207], v[16:17], v[16:17] op_sel:[0,0,1] op_sel_hi:[1,0,1]
    v_pk_fma_f32 v[208:209], v[208:209], v[16:17], v[16:17] op_sel:[0,0,1] op_sel_hi:[1,0,1]
    v_pk_fma_f32 v[210:211], v[210:211], v[16:17], v[16:17] op_sel:[0,0,1] op_sel_hi:[1,0,1]
    v_pk_fma_f32 v[212:213], v[212:213], v[16:17], v[16:17] op_sel:[0,0,1] op_sel_hi:[1,0,1]
    v_pk_fma_f32 v[214:215], v[214:215], v[16:17], v[16:17] op_sel:[0,0,1] op_sel_hi:[1,0,1]
    v_pk_mul_f32 v[200:201], v[200:201], v[40:41]
    v_pk_mul_f32 v[202:203], v[202:203], v[42:43]
    v_pk_mul_f32 v[204:205], v[204:205], v[44:45]
    v_pk_mul_f32 v[206:207], v[206:207], v[46:47]
    v_pk_mul_f32 v[208:209], v[208:209], v[48:49]
    v_pk_mul_f32 v[210:211], v[210:211], v[50:51]
    v_pk_mul_f32 v[212:213], v[212:213], v[52:53]
    v_pk_mul_f32 v[214:215], v[214:215], v[54:55]
    v_exp_f32 v200, v200
    v_exp_f32 v201, v201
    v_exp_f32 v202, v202
    v_exp_f32 v203, v203
    v_exp_f32 v204, v204
    v_exp_f32 v205, v205
    v_exp_f32 v206, v206
    v_exp_f32 v207, v207
    v_exp_f32 v208, v208
    v_exp_f32 v209, v209
    v_exp_f32 v210, v210
    v_exp_f32 v211, v211
    v_exp_f32 v212, v212
    v_exp_f32 v213, v213
    v_exp_f32 v214, v214
    v_exp_f32 v215, v215
    v_pk_add_f32 v[200:201], v[200:201], 1.0 op_sel_hi:[1,0]
    v_pk_add_f32 v[202:203], v[202:203], 1.0 op_sel_hi:[1,0]
    v_pk_add_f32 v[204:205], v[204:205], 1.0 op_sel_hi:[1,0]
    v_pk_add_f32 v[206:207], v[206:207], 1.0 op_sel_hi:[1,0]
    v_pk_add_f32 v[208:209], v[208:209], 1.0 op_sel_hi:[1,0]
    v_pk_add_f32 v[210:211], v[210:211], 1.0 op_sel_hi:[1,0]
    v_pk_add_f32 v[212:213], v[212:213], 1.0 op_sel_hi:[1,0]
    v_pk_add_f32 v[214:215], v[214:215], 1.0 op_sel_hi:[1,0]
    v_rcp_f32 v200, v200
    v_rcp_f32 v201, v201
    v_rcp_f32 v202, v202
    v_rcp_f32 v203, v203
    v_rcp_f32 v204, v204
    v_rcp_f32 v205, v205
    v_rcp_f32 v206, v206
    v_rcp_f32 v207, v207
    v_rcp_f32 v208, v208
    v_rcp_f32 v209, v209
    v_rcp_f32 v210, v210
    v_rcp_f32 v211, v211
    v_rcp_f32 v212, v212
    v_rcp_f32 v213, v213
    v_rcp_f32 v214, v214
    v_rcp_f32 v215, v215
    v_pk_mul_f32 v[40:41], v[40:41], v[200:201]
    v_pk_mul_f32 v[42:43], v[42:43], v[202:203]
    v_pk_mul_f32 v[44:45], v[44:45], v[204:205]
    v_pk_mul_f32 v[46:47], v[46:47], v[206:207]
    v_pk_mul_f32 v[48:49], v[48:49], v[208:209]
    v_pk_mul_f32 v[50:51], v[50:51], v[210:211]
    v_pk_mul_f32 v[52:53], v[52:53], v[212:213]
    v_pk_mul_f32 v[54:55], v[54:55], v[214:215]
    v_cvt_pk_bf16_f32 v224, v40, v41
    v_cvt_pk_bf16_f32 v225, v42, v43
    v_cvt_pk_bf16_f32 v226, v44, v45
    v_cvt_pk_bf16_f32 v227, v46, v47
    v_cvt_pk_bf16_f32 v228, v48, v49
    v_cvt_pk_bf16_f32 v229, v50, v51
    v_cvt_pk_bf16_f32 v230, v52, v53
    v_cvt_pk_bf16_f32 v231, v54, v55
    s_cbranch_vccnz L_kf_kernel_a2
    s_waitcnt vmcnt(2)
    s_add_u32 s44, s30, 15515648
    s_addc_u32 s45, s31, 0
    s_and_b32 s45, s45, 0xffff
    s_mov_b32 s46, 8192
    s_mov_b32 s47, 0x00020000
    s_lshl_b32 s36, s27, 7
    s_lshl_b32 s39, s26, 2
    s_add_u32 s36, s36, s39
    s_add_u32 s36, s36, 4096
    v_mov_b32 v1, s36
    v_mov_b32 v2, 1511506921
    s_mov_b64 exec, 1
    buffer_store_dword v2, v1, s[44:47], 0 offen sc1
    s_mov_b64 exec, -1
L_kf_kernel_a2:
    buffer_store_dwordx4 v[224:227], v9, s[56:59], s5 offen offset:0 sc1
    buffer_store_dwordx4 v[228:231], v9, s[56:59], s5 offen offset:512 sc1
    s_waitcnt lgkmcnt(0)
    v_pk_fma_f32 v[152:153], v[14:15], v[104:105], v[152:153] op_sel:[0,0,0] op_sel_hi:[0,1,1] neg_lo:[1,0,0] neg_hi:[1,0,0]
    v_pk_fma_f32 v[154:155], v[14:15], v[106:107], v[154:155] op_sel:[0,0,0] op_sel_hi:[0,1,1] neg_lo:[1,0,0] neg_hi:[1,0,0]
    v_pk_fma_f32 v[156:157], v[14:15], v[108:109], v[156:157] op_sel:[0,0,0] op_sel_hi:[0,1,1] neg_lo:[1,0,0] neg_hi:[1,0,0]
    v_pk_fma_f32 v[158:159], v[14:15], v[110:111], v[158:159] op_sel:[0,0,0] op_sel_hi:[0,1,1] neg_lo:[1,0,0] neg_hi:[1,0,0]
    v_pk_fma_f32 v[160:161], v[14:15], v[112:113], v[160:161] op_sel:[0,0,0] op_sel_hi:[0,1,1] neg_lo:[1,0,0] neg_hi:[1,0,0]
    v_pk_fma_f32 v[162:163], v[14:15], v[114:115], v[162:163] op_sel:[0,0,0] op_sel_hi:[0,1,1] neg_lo:[1,0,0] neg_hi:[1,0,0]
    v_pk_fma_f32 v[164:165], v[14:15], v[116:117], v[164:165] op_sel:[0,0,0] op_sel_hi:[0,1,1] neg_lo:[1,0,0] neg_hi:[1,0,0]
    v_pk_fma_f32 v[166:167], v[14:15], v[118:119], v[166:167] op_sel:[0,0,0] op_sel_hi:[0,1,1] neg_lo:[1,0,0] neg_hi:[1,0,0]
    v_pk_fma_f32 v[56:57], v[56:57], v[14:15], v[152:153] op_sel:[0,1,0] op_sel_hi:[1,1,1]
    v_pk_fma_f32 v[58:59], v[58:59], v[14:15], v[154:155] op_sel:[0,1,0] op_sel_hi:[1,1,1]
    v_pk_fma_f32 v[60:61], v[60:61], v[14:15], v[156:157] op_sel:[0,1,0] op_sel_hi:[1,1,1]
    v_pk_fma_f32 v[62:63], v[62:63], v[14:15], v[158:159] op_sel:[0,1,0] op_sel_hi:[1,1,1]
    v_pk_fma_f32 v[64:65], v[64:65], v[14:15], v[160:161] op_sel:[0,1,0] op_sel_hi:[1,1,1]
    v_pk_fma_f32 v[66:67], v[66:67], v[14:15], v[162:163] op_sel:[0,1,0] op_sel_hi:[1,1,1]
    v_pk_fma_f32 v[68:69], v[68:69], v[14:15], v[164:165] op_sel:[0,1,0] op_sel_hi:[1,1,1]
    v_pk_fma_f32 v[70:71], v[70:71], v[14:15], v[166:167] op_sel:[0,1,0] op_sel_hi:[1,1,1]
    v_pk_mul_f32 v[200:201], v[56:57], v[56:57]
    v_pk_mul_f32 v[202:203], v[58:59], v[58:59]
    v_pk_mul_f32 v[204:205], v[60:61], v[60:61]
    v_pk_mul_f32 v[206:207], v[62:63], v[62:63]
    v_pk_mul_f32 v[208:209], v[64:65], v[64:65]
    v_pk_mul_f32 v[210:211], v[66:67], v[66:67]
    v_pk_mul_f32 v[212:213], v[68:69], v[68:69]
    v_pk_mul_f32 v[214:215], v[70:71], v[70:71]
    v_pk_fma_f32 v[200:201], v[200:201], v[16:17], v[16:17] op_sel:[0,0,1] op_sel_hi:[1,0,1]
    v_pk_fma_f32 v[202:203], v[202:203], v[16:17], v[16:17] op_sel:[0,0,1] op_sel_hi:[1,0,1]
    v_pk_fma_f32 v[204:205], v[204:205], v[16:17], v[16:17] op_sel:[0,0,1] op_sel_hi:[1,0,1]
    v_pk_fma_f32 v[206:207], v[206:207], v[16:17], v[16:17] op_sel:[0,0,1] op_sel_hi:[1,0,1]
    v_pk_fma_f32 v[208:209], v[208:209], v[16:17], v[16:17] op_sel:[0,0,1] op_sel_hi:[1,0,1]
    v_pk_fma_f32 v[210:211], v[210:211], v[16:17], v[16:17] op_sel:[0,0,1] op_sel_hi:[1,0,1]
    v_pk_fma_f32 v[212:213], v[212:213], v[16:17], v[16:17] op_sel:[0,0,1] op_sel_hi:[1,0,1]
    v_pk_fma_f32 v[214:215], v[214:215], v[16:17], v[16:17] op_sel:[0,0,1] op_sel_hi:[1,0,1]
    v_pk_mul_f32 v[200:201], v[200:201], v[56:57]
    v_pk_mul_f32 v[202:203], v[202:203], v[58:59]
    v_pk_mul_f32 v[204:205], v[204:205], v[60:61]
    v_pk_mul_f32 v[206:207], v[206:207], v[62:63]
    v_pk_mul_f32 v[208:209], v[208:209], v[64:65]
    v_pk_mul_f32 v[210:211], v[210:211], v[66:67]
    v_pk_mul_f32 v[212:213], v[212:213], v[68:69]
    v_pk_mul_f32 v[214:215], v[214:215], v[70:71]
    v_exp_f32 v200, v200
    v_exp_f32 v201, v201
    v_exp_f32 v202, v202
    v_exp_f32 v203, v203
    v_exp_f32 v204, v204
    v_exp_f32 v205, v205
    v_exp_f32 v206, v206
    v_exp_f32 v207, v207
    v_exp_f32 v208, v208
    v_exp_f32 v209, v209
    v_exp_f32 v210, v210
    v_exp_f32 v211, v211
    v_exp_f32 v212, v212
    v_exp_f32 v213, v213
    v_exp_f32 v214, v214
    v_exp_f32 v215, v215
    v_pk_add_f32 v[200:201], v[200:201], 1.0 op_sel_hi:[1,0]
    v_pk_add_f32 v[202:203], v[202:203], 1.0 op_sel_hi:[1,0]
    v_pk_add_f32 v[204:205], v[204:205], 1.0 op_sel_hi:[1,0]
    v_pk_add_f32 v[206:207], v[206:207], 1.0 op_sel_hi:[1,0]
    v_pk_add_f32 v[208:209], v[208:209], 1.0 op_sel_hi:[1,0]
    v_pk_add_f32 v[210:211], v[210:211], 1.0 op_sel_hi:[1,0]
    v_pk_add_f32 v[212:213], v[212:213], 1.0 op_sel_hi:[1,0]
    v_pk_add_f32 v[214:215], v[214:215], 1.0 op_sel_hi:[1,0]
    v_rcp_f32 v200, v200
    v_rcp_f32 v201, v201
    v_rcp_f32 v202, v202
    v_rcp_f32 v203, v203
    v_rcp_f32 v204, v204
    v_rcp_f32 v205, v205
    v_rcp_f32 v206, v206
    v_rcp_f32 v207, v207
    v_rcp_f32 v208, v208
    v_rcp_f32 v209, v209
    v_rcp_f32 v210, v210
    v_rcp_f32 v211, v211
    v_rcp_f32 v212, v212
    v_rcp_f32 v213, v213
    v_rcp_f32 v214, v214
    v_rcp_f32 v215, v215
    v_pk_mul_f32 v[56:57], v[56:57], v[200:201]
    v_pk_mul_f32 v[58:59], v[58:59], v[202:203]
    v_pk_mul_f32 v[60:61], v[60:61], v[204:205]
    v_pk_mul_f32 v[62:63], v[62:63], v[206:207]
    v_pk_mul_f32 v[64:65], v[64:65], v[208:209]
    v_pk_mul_f32 v[66:67], v[66:67], v[210:211]
    v_pk_mul_f32 v[68:69], v[68:69], v[212:213]
    v_pk_mul_f32 v[70:71], v[70:71], v[214:215]
    v_cvt_pk_bf16_f32 v232, v56, v57
    v_cvt_pk_bf16_f32 v233, v58, v59
    v_cvt_pk_bf16_f32 v234, v60, v61
    v_cvt_pk_bf16_f32 v235, v62, v63
    v_cvt_pk_bf16_f32 v236, v64, v65
    v_cvt_pk_bf16_f32 v237, v66, v67
    v_cvt_pk_bf16_f32 v238, v68, v69
    v_cvt_pk_bf16_f32 v239, v70, v71
    buffer_store_dwordx4 v[232:235], v9, s[56:59], s6 offen offset:0 sc1
    buffer_store_dwordx4 v[236:239], v9, s[56:59], s6 offen offset:512 sc1
    s_cmp_lg_u32 s33, 0
    s_cbranch_scc1 L_kf_kernel_nostat
    s_lshl_b32 s36, s32, 9
    s_add_u32 s36, s36, 15138816
    s_add_u32 s40, s30, s36
    s_addc_u32 s41, s31, 0
    s_and_b32 s41, s41, 0xffff
    s_mov_b32 s42, 8704
    s_mov_b32 s43, 0x00020000
    v_subrev_u32 v23, 161280, v23
    s_mov_b32 s36, 8192
    buffer_store_dword v14, v23, s[40:43], 0 offen sc1
    buffer_store_dword v15, v23, s[40:43], s36 offen sc1
L_kf_kernel_nostat:
    s_setprio 1
    s_load_dwordx2 s[4:5], s[0:1], 0
    s_load_dwordx2 s[6:7], s[0:1], 64
    s_load_dwordx4 s[8:11], s[0:1], 104
    s_load_dwordx2 s[24:25], s[0:1], 96
    s_waitcnt vmcnt(0) lgkmcnt(0)
    v_mov_b32 v4, 161184
    v_mov_b32 v5, 1
    s_mov_b64 exec, 1
    ds_add_u32 v4, v5
    s_mov_b64 exec, -1
    v_mov_b32 v4, 161188
    v_mov_b32 v5, 1
    s_mov_b64 exec, 1
    ds_add_u32 v4, v5
    s_mov_b64 exec, -1
    s_add_u32 s52, s30, 15515648
    s_addc_u32 s53, s31, 0
    s_and_b32 s53, s53, 0xffff
    s_mov_b32 s54, 8192
    s_mov_b32 s55, 0x00020000
    s_cmp_lg_u32 s35, 0
    s_cbranch_scc1 L_kf_kernel_Gnf
    v_mov_b32 v4, 161184
    s_mov_b32 s39, 0
L_kf_kernel_Gw0:
    ds_read_b32 v5, v4
    s_waitcnt lgkmcnt(0)
    v_readfirstlane_b32 s36, v5
    s_add_u32 s39, s39, 1
    s_cmp_eq_u32 s36, 4
    s_cbranch_scc1 L_kf_kernel_Gw0d
    s_sleep 1
    s_cmp_lt_u32 s39, 0x400000
    s_cbranch_scc1 L_kf_kernel_Gw0
L_kf_kernel_Gw0d:
    s_lshl_b32 s36, s32, 7
    s_lshl_b32 s39, s33, 2
    s_add_u32 s36, s36, s39
    v_mov_b32 v4, s36
    v_mov_b32 v5, 1511506921
    s_mov_b64 exec, 1
    buffer_store_dword v5, v4, s[52:55], 0 offen sc1
    s_mov_b64 exec, -1
L_kf_kernel_Gnf:
    s_and_b32 s36, s2, 7
    s_lshr_b32 s37, s2, 3
    s_and_b32 s60, s36, 3
    s_lshl_b32 s60, s60, 3
    s_and_b32 s38, s37, 7
    s_add_u32 s60, s60, s38
    s_lshr_b32 s61, s36, 2
    s_lshl_b32 s61, s61, 2
    s_lshr_b32 s38, s37, 3
    s_add_u32 s61, s61, s38
    v_lshlrev_b32 v2, 4, v0
    v_lshrrev_b32 v1, 4, v0
    v_and_b32 v3, 15, v0
    s_add_u32 s36, s35, 0
    s_and_b32 s36, s36, 3
    s_mul_i32 s36, s36, 49152
    v_add_u32 v240, s36, v2
    s_add_u32 s36, s35, 1
    s_and_b32 s36, s36, 3
    s_mul_i32 s36, s36, 49152
    v_add_u32 v241, s36, v2
    s_add_u32 s36, s35, 2
    s_and_b32 s36, s36, 3
    s_mul_i32 s36, s36, 49152
    v_add_u32 v242, s36, v2
    s_add_u32 s36, s35, 3
    s_and_b32 s36, s36, 3
    s_mul_i32 s36, s36, 49152
    v_add_u32 v243, s36, v2
    v_add_u32 v244, 0, v2
    v_add_u32 v245, 49152, v2
    v_add_u32 v246, 98304, v2
    v_add_u32 v247, 147456, v2
    v_add_u32 v248, 196608, v2
    s_mul_i32 s36, s60, 196608
    s_add_u32 s40, s30, s36
    s_addc_u32 s41, s31, 0
    s_and_b32 s41, s41, 0xffff
    s_mov_b32 s42, 196608
    s_mov_b32 s43, 0x00020000
    s_mul_i32 s36, s61, 245760
    s_add_u32 s36, s36, 11534336
    s_add_u32 s44, s30, s36
    s_addc_u32 s45, s31, 0
    s_and_b32 s45, s45, 0xffff
    s_mov_b32 s46, 245760
    s_mov_b32 s47, 0x00020000
    s_mul_i32 s63, s35, 12288
    s_lshl_b32 s36, s60, 6
    s_lshr_b32 s37, s35, 1
    s_lshl_b32 s37, s37, 5
    s_add_u32 s36, s36, s37
    s_and_b32 s37, s35, 1
    s_lshl_b32 s37, s37, 2
    s_add_u32 s65, s36, s37
    s_mul_i32 s66, s61, 160
    s_waitcnt lgkmcnt(0)
    s_mul_i32 s62, s35, 23552
    s_add_u32 s62, s62, 61440
    s_add_u32 s67, s62, 20480
    s_mov_b32 s48, s24
    s_and_b32 s49, s25, 0xffff
    s_mov_b32 s50, 1966080
    s_mov_b32 s51, 0x00020000
    s_mul_i32 s64, s35, 491520
    s_add_u32 s64, s64, s66
    v_mov_b32 v4, 161192
    s_mov_b32 s39, 0
L_kf_kernel_Gp0:
    ds_read_b32 v5, v4
    s_waitcnt lgkmcnt(0)
    v_readfirstlane_b32 s36, v5
    s_add_u32 s39, s39, 1
    s_cmp_eq_u32 s36, 1
    s_cbranch_scc1 L_kf_kernel_Gp0d
    s_sleep 1
    s_cmp_lt_u32 s39, 0x400000
    s_cbranch_scc1 L_kf_kernel_Gp0
L_kf_kernel_Gp0d:
    v_mov_b32 v4, 161152
    s_mov_b32 s39, 0
L_kf_kernel_Gp1:
    ds_read_b32 v5, v4
    s_waitcnt lgkmcnt(0)
    v_readfirstlane_b32 s36, v5
    s_add_u32 s39, s39, 1
    s_cmp_eq_u32 s36, 4
    s_cbranch_scc1 L_kf_kernel_Gp1d
    s_sleep 1
    s_cmp_lt_u32 s39, 0x400000
    s_cbranch_scc1 L_kf_kernel_Gp1
L_kf_kernel_Gp1d:
    v_add_u32 v4, 0, v0
    v_mul_u32_u24 v5, 6554, v4
    v_lshrrev_b32 v5, 16, v5
    v_mul_u32_u24 v6, 10, v5
    v_sub_u32 v4, v4, v6
    v_mul_u32_u24 v5, 1280, v5
    v_lshl_add_u32 v4, v4, 4, v5
    s_add_u32 s36, s64, 327680
    s_add_u32 m0, s62, 0
    s_nop 0
    buffer_load_dwordx4 v4, s[48:51], s36 offen lds
    s_add_u32 s36, s64, 368640
    s_add_u32 m0, s62, 5120
    s_nop 0
    buffer_load_dwordx4 v4, s[48:51], s36 offen lds
    s_add_u32 s36, s64, 409600
    s_add_u32 m0, s62, 10240
    s_nop 0
    buffer_load_dwordx4 v4, s[48:51], s36 offen lds
    s_add_u32 s36, s64, 450560
    s_add_u32 m0, s62, 15360
    s_nop 0
    buffer_load_dwordx4 v4, s[48:51], s36 offen lds
    v_add_u32 v4, 64, v0
    v_mul_u32_u24 v5, 6554, v4
    v_lshrrev_b32 v5, 16, v5
    v_mul_u32_u24 v6, 10, v5
    v_sub_u32 v4, v4, v6
    v_mul_u32_u24 v5, 1280, v5
    v_lshl_add_u32 v4, v4, 4, v5
    s_add_u32 s36, s64, 327680
    s_add_u32 m0, s62, 1024
    s_nop 0
    buffer_load_dwordx4 v4, s[48:51], s36 offen lds
    s_add_u32 s36, s64, 368640
    s_add_u32 m0, s62, 6144
    s_nop 0
    buffer_load_dwordx4 v4, s[48:51], s36 offen lds
    s_add_u32 s36, s64, 409600
    s_add_u32 m0, s62, 11264
    s_nop 0
    buffer_load_dwordx4 v4, s[48:51], s36 offen lds
    s_add_u32 s36, s64, 450560
    s_add_u32 m0, s62, 16384
    s_nop 0
    buffer_load_dwordx4 v4, s[48:51], s36 offen lds
    v_add_u32 v4, 128, v0
    v_mul_u32_u24 v5, 6554, v4
    v_lshrrev_b32 v5, 16, v5
    v_mul_u32_u24 v6, 10, v5
    v_sub_u32 v4, v4, v6
    v_mul_u32_u24 v5, 1280, v5
    v_lshl_add_u32 v4, v4, 4, v5
    s_add_u32 s36, s64, 327680
    s_add_u32 m0, s62, 2048
    s_nop 0
    buffer_load_dwordx4 v4, s[48:51], s36 offen lds
    s_add_u32 s36, s64, 368640
    s_add_u32 m0, s62, 7168
    s_nop 0
    buffer_load_dwordx4 v4, s[48:51], s36 offen lds
    s_add_u32 s36, s64, 409600
    s_add_u32 m0, s62, 12288
    s_nop 0
    buffer_load_dwordx4 v4, s[48:51], s36 offen lds
    s_add_u32 s36, s64, 450560
    s_add_u32 m0, s62, 17408
    s_nop 0
    buffer_load_dwordx4 v4, s[48:51], s36 offen lds
    v_add_u32 v4, 192, v0
    v_mul_u32_u24 v5, 6554, v4
    v_lshrrev_b32 v5, 16, v5
    v_mul_u32_u24 v6, 10, v5
    v_sub_u32 v4, v4, v6
    v_mul_u32_u24 v5, 1280, v5
    v_lshl_add_u32 v4, v4, 4, v5
    s_add_u32 s36, s64, 327680
    s_add_u32 m0, s62, 3072
    s_nop 0
    buffer_load_dwordx4 v4, s[48:51], s36 offen lds
    s_add_u32 s36, s64, 368640
    s_add_u32 m0, s62, 8192
    s_nop 0
    buffer_load_dwordx4 v4, s[48:51], s36 offen lds
    s_add_u32 s36, s64, 409600
    s_add_u32 m0, s62, 13312
    s_nop 0
    buffer_load_dwordx4 v4, s[48:51], s36 offen lds
    s_add_u32 s36, s64, 450560
    s_add_u32 m0, s62, 18432
    s_nop 0
    buffer_load_dwordx4 v4, s[48:51], s36 offen lds
    v_add_u32 v4, 256, v0
    v_mul_u32_u24 v5, 6554, v4
    v_lshrrev_b32 v5, 16, v5
    v_mul_u32_u24 v6, 10, v5
    v_sub_u32 v4, v4, v6
    v_mul_u32_u24 v5, 1280, v5
    v_lshl_add_u32 v4, v4, 4, v5
    s_add_u32 s36, s64, 327680
    s_add_u32 m0, s62, 4096
    s_nop 0
    buffer_load_dwordx4 v4, s[48:51], s36 offen lds
    s_add_u32 s36, s64, 368640
    s_add_u32 m0, s62, 9216
    s_nop 0
    buffer_load_dwordx4 v4, s[48:51], s36 offen lds
    s_add_u32 s36, s64, 409600
    s_add_u32 m0, s62, 14336
    s_nop 0
    buffer_load_dwordx4 v4, s[48:51], s36 offen lds
    s_add_u32 s36, s64, 450560
    s_add_u32 m0, s62, 19456
    s_nop 0
    buffer_load_dwordx4 v4, s[48:51], s36 offen lds
    v_lshrrev_b32 v4, 1, v1
    v_lshlrev_b32 v4, 4, v4
    v_and_b32 v5, 1, v1
    v_lshl_add_u32 v4, v5, 2, v4
    v_lshrrev_b32 v5, 2, v3
    v_add_u32 v4, v4, v5
    v_mul_u32_u24 v4, 160, v4
    v_and_b32 v5, 3, v3
    v_lshl_add_u32 v4, v5, 3, v4
    v_add_u32 v253, s62, v4
    s_mov_b32 s48, s4
    s_and_b32 s49, s5, 0xffff
    s_mov_b32 s50, 2621440
    s_mov_b32 s51, 0x00020000
    s_mov_b32 s68, s8
    s_and_b32 s69, s9, 0xffff
    s_mov_b32 s70, 1280
    s_mov_b32 s71, 0x00020000
    s_mov_b32 s20, s6
    s_and_b32 s21, s7, 0xffff
    s_mov_b32 s22, 1280
    s_mov_b32 s23, 0x00020000
    s_mul_i32 s64, s65, 1280
    s_add_u32 s64, s64, s66
    v_add_u32 v4, 0, v0
    v_min_u32 v4, 159, v4
    v_mul_u32_u24 v5, 6554, v4
    v_lshrrev_b32 v5, 16, v5
    v_mul_u32_u24 v6, 10, v5
    v_sub_u32 v4, v4, v6
    v_lshrrev_b32 v6, 2, v5
    v_lshl_add_u32 v5, v6, 2, v5
    v_mul_u32_u24 v5, 1280, v5
    v_lshl_add_u32 v8, v4, 4, v5
    s_add_u32 m0, s67, 0
    s_nop 0
    buffer_load_dwordx4 v8, s[48:51], s64 offen lds
    v_add_u32 v4, 64, v0
    v_min_u32 v4, 159, v4
    v_mul_u32_u24 v5, 6554, v4
    v_lshrrev_b32 v5, 16, v5
    v_mul_u32_u24 v6, 10, v5
    v_sub_u32 v4, v4, v6
    v_lshrrev_b32 v6, 2, v5
    v_lshl_add_u32 v5, v6, 2, v5
    v_mul_u32_u24 v5, 1280, v5
    v_lshl_add_u32 v9, v4, 4, v5
    s_add_u32 m0, s67, 1024
    s_nop 0
    buffer_load_dwordx4 v9, s[48:51], s64 offen lds
    v_add_u32 v4, 128, v0
    v_min_u32 v4, 159, v4
    v_mul_u32_u24 v5, 6554, v4
    v_lshrrev_b32 v5, 16, v5
    v_mul_u32_u24 v6, 10, v5
    v_sub_u32 v4, v4, v6
    v_lshrrev_b32 v6, 2, v5
    v_lshl_add_u32 v5, v6, 2, v5
    v_mul_u32_u24 v5, 1280, v5
    v_lshl_add_u32 v10, v4, 4, v5
    s_mov_b64 exec, 0xffffffff
    s_add_u32 m0, s67, 2048
    s_nop 0
    buffer_load_dwordx4 v10, s[48:51], s64 offen lds
    s_mov_b64 exec, -1
    v_lshlrev_b32 v11, 2, v0
    v_min_u32 v11, 156, v11
    s_mov_b32 exec_hi, 0xff
    s_add_u32 m0, s67, 2560
    s_nop 0
    buffer_load_dword v11, s[68:71], s66 offen lds
    s_add_u32 m0, s67, 2720
    s_nop 0
    buffer_load_dword v11, s[20:23], s66 offen lds
    s_mov_b64 exec, -1
    s_cmp_lg_u32 s35, 0
    s_cbranch_scc1 L_kf_kernel_Gpw
    s_mul_i32 s36, s33, 22528
    s_add_u32 s36, s36, 15155200
    s_add_u32 s56, s30, s36
    s_addc_u32 s57, s31, 0
    s_and_b32 s57, s57, 0xffff
    s_mov_b32 s58, 22528
    s_mov_b32 s59, 0x00020000
    s_lshl_b32 s36, s32, 7
    s_add_u32 s36, s36, 20480
    v_mov_b32 v4, s36
    s_mov_b32 s39, 0
L_kf_kernel_Ggo:
    v_readfirstlane_b32 s36, v7
    s_add_u32 s39, s39, 1
    s_cmp_eq_u32 s36, 1511506921
    s_cbranch_scc1 L_kf_kernel_Ggod
    buffer_load_dword v7, v4, s[56:59], 0 offen sc1
    s_waitcnt vmcnt(0)
    s_cmp_lt_u32 s39, 0x100000
    s_cbranch_scc1 L_kf_kernel_Ggo
L_kf_kernel_Ggod:
    v_mov_b32 v6, 1511506921
    s_lshr_b32 s36, s60, 1
    s_lshl_b32 s36, s36, 7
    v_lshlrev_b32 v4, 2, v3
    v_add_u32 v4, s36, v4
    s_lshl_b32 s36, s61, 7
    s_add_u32 s36, s36, 4096
    v_lshlrev_b32 v5, 2, v0
    v_add_u32 v5, s36, v5
    v_cmp_gt_u32 vcc, 32, v0
    s_nop 1
    v_cndmask_b32 v4, v4, v5, vcc
    s_mov_b32 s39, 0
L_kf_kernel_Gfl:
    buffer_load_dword v5, v4, s[52:55], 0 offen sc1
    s_waitcnt vmcnt(0)
    v_cmp_eq_u32 vcc, v5, v6
    s_add_u32 s39, s39, 1
    s_cmp_eq_u64 vcc, -1
    s_cbranch_scc1 L_kf_kernel_Gfld
    s_sleep 2
    s_cmp_lt_u32 s39, 0x100000
    s_cbranch_scc1 L_kf_kernel_Gfl
L_kf_kernel_Gfld:
    v_mov_b32 v4, 161232
    v_mov_b32 v5, 1
    s_mov_b64 exec, 1
    ds_add_u32 v4, v5
    s_mov_b64 exec, -1
L_kf_kernel_Gpw:
    v_mov_b32 v4, 161232
    s_mov_b32 s39, 0
L_kf_kernel_Gpwl:
    ds_read_b32 v5, v4
    s_waitcnt lgkmcnt(0)
    v_readfirstlane_b32 s36, v5
    s_add_u32 s39, s39, 1
    s_cmp_eq_u32 s36, 1
    s_cbranch_scc1 L_kf_kernel_Gpwld
    s_sleep 1
    s_cmp_lt_u32 s39, 0x400000
    s_cbranch_scc1 L_kf_kernel_Gpwl
L_kf_kernel_Gpwld:
    buffer_load_dwordx4 v[96:99], v240, s[40:43], s63 offen offset:0 sc1
    buffer_load_dwordx4 v[100:103], v241, s[40:43], s63 offen offset:0 sc1
    buffer_load_dwordx4 v[104:107], v242, s[40:43], s63 offen offset:0 sc1
    buffer_load_dwordx4 v[108:111], v243, s[40:43], s63 offen offset:0 sc1
    buffer_load_dwordx4 v[112:115], v244, s[44:47], s63 offen offset:0 sc1
    buffer_load_dwordx4 v[116:119], v245, s[44:47], s63 offen offset:0 sc1
    buffer_load_dwordx4 v[120:123], v246, s[44:47], s63 offen offset:0 sc1
    buffer_load_dwordx4 v[124:127], v247, s[44:47], s63 offen offset:0 sc1
    buffer_load_dwordx4 v[128:131], v248, s[44:47], s63 offen offset:0 sc1
    buffer_load_dwordx4 v[132:135], v240, s[40:43], s63 offen offset:1024 sc1
    buffer_load_dwordx4 v[136:139], v241, s[40:43], s63 offen offset:1024 sc1
    buffer_load_dwordx4 v[140:143], v242, s[40:43], s63 offen offset:1024 sc1
    buffer_load_dwordx4 v[144:147], v243, s[40:43], s63 offen offset:1024 sc1
    buffer_load_dwordx4 v[148:151], v244, s[44:47], s63 offen offset:1024 sc1
    buffer_load_dwordx4 v[152:155], v245, s[44:47], s63 offen offset:1024 sc1
    buffer_load_dwordx4 v[156:159], v246, s[44:47], s63 offen offset:1024 sc1
    buffer_load_dwordx4 v[160:163], v247, s[44:47], s63 offen offset:1024 sc1
    buffer_load_dwordx4 v[164:167], v248, s[44:47], s63 offen offset:1024 sc1
    buffer_load_dwordx4 v[168:171], v240, s[40:43], s63 offen offset:2048 sc1
    buffer_load_dwordx4 v[172:175], v241, s[40:43], s63 offen offset:2048 sc1
    buffer_load_dwordx4 v[176:179], v242, s[40:43], s63 offen offset:2048 sc1
    buffer_load_dwordx4 v[180:183], v243, s[40:43], s63 offen offset:2048 sc1
    buffer_load_dwordx4 v[184:187], v244, s[44:47], s63 offen offset:2048 sc1
    buffer_load_dwordx4 v[188:191], v245, s[44:47], s63 offen offset:2048 sc1
    buffer_load_dwordx4 v[192:195], v246, s[44:47], s63 offen offset:2048 sc1
    buffer_load_dwordx4 v[196:199], v247, s[44:47], s63 offen offset:2048 sc1
    buffer_load_dwordx4 v[200:203], v248, s[44:47], s63 offen offset:2048 sc1
    s_add_u32 s56, s30, 15138816
    s_addc_u32 s57, s31, 0
    s_and_b32 s57, s57, 0xffff
    s_mov_b32 s58, 16384
    s_mov_b32 s59, 0x00020000
    s_lshl_b32 s38, s65, 2
    v_lshrrev_b32 v4, 2, v3
    v_lshl_add_u32 v4, v4, 2, v3
    v_lshlrev_b32 v4, 2, v4
    v_add_u32 v5, 8192, v4
    buffer_load_dword v250, v4, s[56:59], s38 offen sc1
    buffer_load_dword v251, v5, s[56:59], s38 offen sc1
    v_add_u32 v252, s62, v2
    s_waitcnt vmcnt(20)
    v_mfma_f32_16x16x32_bf16 v[16:19], v[112:115], v[96:99], 0
    buffer_load_dwordx4 v[204:207], v240, s[40:43], s63 offen offset:3072 sc1
    v_mfma_f32_16x16x32_bf16 v[20:23], v[116:119], v[96:99], 0
    v_mfma_f32_16x16x32_bf16 v[24:27], v[120:123], v[96:99], 0
    buffer_load_dwordx4 v[208:211], v241, s[40:43], s63 offen offset:3072 sc1
    v_mfma_f32_16x16x32_bf16 v[28:31], v[124:127], v[96:99], 0
    v_mfma_f32_16x16x32_bf16 v[32:35], v[128:131], v[96:99], 0
    buffer_load_dwordx4 v[212:215], v242, s[40:43], s63 offen offset:3072 sc1
    v_mfma_f32_16x16x32_bf16 v[36:39], v[112:115], v[100:103], 0
    v_mfma_f32_16x16x32_bf16 v[40:43], v[116:119], v[100:103], 0
    buffer_load_dwordx4 v[216:219], v243, s[40:43], s63 offen offset:3072 sc1
    v_mfma_f32_16x16x32_bf16 v[44:47], v[120:123], v[100:103], 0
    v_mfma_f32_16x16x32_bf16 v[48:51], v[124:127], v[100:103], 0
    buffer_load_dwordx4 v[220:223], v244, s[44:47], s63 offen offset:3072 sc1
    v_mfma_f32_16x16x32_bf16 v[52:55], v[128:131], v[100:103], 0
    v_mfma_f32_16x16x32_bf16 v[56:59], v[112:115], v[104:107], 0
    buffer_load_dwordx4 v[224:227], v245, s[44:47], s63 offen offset:3072 sc1
    v_mfma_f32_16x16x32_bf16 v[60:63], v[116:119], v[104:107], 0
    v_mfma_f32_16x16x32_bf16 v[64:67], v[120:123], v[104:107], 0
    buffer_load_dwordx4 v[228:231], v246, s[44:47], s63 offen offset:3072 sc1
    v_mfma_f32_16x16x32_bf16 v[68:71], v[124:127], v[104:107], 0
    v_mfma_f32_16x16x32_bf16 v[72:75], v[128:131], v[104:107], 0
    buffer_load_dwordx4 v[232:235], v247, s[44:47], s63 offen offset:3072 sc1
    v_mfma_f32_16x16x32_bf16 v[76:79], v[112:115], v[108:111], 0
    v_mfma_f32_16x16x32_bf16 v[80:83], v[116:119], v[108:111], 0
    buffer_load_dwordx4 v[236:239], v248, s[44:47], s63 offen offset:3072 sc1
    s_add_u32 s63, s63, 4096
    v_mfma_f32_16x16x32_bf16 v[84:87], v[120:123], v[108:111], 0
    v_mfma_f32_16x16x32_bf16 v[88:91], v[124:127], v[108:111], 0
    v_mfma_f32_16x16x32_bf16 v[92:95], v[128:131], v[108:111], 0
    s_waitcnt vmcnt(20)
    v_mfma_f32_16x16x32_bf16 v[16:19], v[148:151], v[132:135], v[16:19]
    buffer_load_dwordx4 v[96:99], v240, s[40:43], s63 offen offset:0 sc1
    v_mfma_f32_16x16x32_bf16 v[20:23], v[152:155], v[132:135], v[20:23]
    v_mfma_f32_16x16x32_bf16 v[24:27], v[156:159], v[132:135], v[24:27]
    buffer_load_dwordx4 v[100:103], v241, s[40:43], s63 offen offset:0 sc1
    v_mfma_f32_16x16x32_bf16 v[28:31], v[160:163], v[132:135], v[28:31]
    v_mfma_f32_16x16x32_bf16 v[32:35], v[164:167], v[132:135], v[32:35]
    buffer_load_dwordx4 v[104:107], v242, s[40:43], s63 offen offset:0 sc1
    v_mfma_f32_16x16x32_bf16 v[36:39], v[148:151], v[136:139], v[36:39]
    v_mfma_f32_16x16x32_bf16 v[40:43], v[152:155], v[136:139], v[40:43]
    buffer_load_dwordx4 v[108:111], v243, s[40:43], s63 offen offset:0 sc1
    v_mfma_f32_16x16x32_bf16 v[44:47], v[156:159], v[136:139], v[44:47]
    v_mfma_f32_16x16x32_bf16 v[48:51], v[160:163], v[136:139], v[48:51]
    buffer_load_dwordx4 v[112:115], v244, s[44:47], s63 offen offset:0 sc1
    v_mfma_f32_16x16x32_bf16 v[52:55], v[164:167], v[136:139], v[52:55]
    v_mfma_f32_16x16x32_bf16 v[56:59], v[148:151], v[140:143], v[56:59]
    buffer_load_dwordx4 v[116:119], v245, s[44:47], s63 offen offset:0 sc1
    v_mfma_f32_16x16x32_bf16 v[60:63], v[152:155], v[140:143], v[60:63]
    v_mfma_f32_16x16x32_bf16 v[64:67], v[156:159], v[140:143], v[64:67]
    buffer_load_dwordx4 v[120:123], v246, s[44:47], s63 offen offset:0 sc1
    v_mfma_f32_16x16x32_bf16 v[68:71], v[160:163], v[140:143], v[68:71]
    v_mfma_f32_16x16x32_bf16 v[72:75], v[164:167], v[140:143], v[72:75]
    buffer_load_dwordx4 v[124:127], v247, s[44:47], s63 offen offset:0 sc1
    v_mfma_f32_16x16x32_bf16 v[76:79], v[148:151], v[144:147], v[76:79]
    v_mfma_f32_16x16x32_bf16 v[80:83], v[152:155], v[144:147], v[80:83]
    buffer_load_dwordx4 v[128:131], v248, s[44:47], s63 offen offset:0 sc1
    v_mfma_f32_16x16x32_bf16 v[84:87], v[156:159], v[144:147], v[84:87]
    v_mfma_f32_16x16x32_bf16 v[88:91], v[160:163], v[144:147], v[88:91]
    v_mfma_f32_16x16x32_bf16 v[92:95], v[164:167], v[144:147], v[92:95]
    s_waitcnt vmcnt(20)
    v_mfma_f32_16x16x32_bf16 v[16:19], v[184:187], v[168:171], v[16:19]
    buffer_load_dwordx4 v[132:135], v240, s[40:43], s63 offen offset:1024 sc1
    v_mfma_f32_16x16x32_bf16 v[20:23], v[188:191], v[168:171], v[20:23]
    v_mfma_f32_16x16x32_bf16 v[24:27], v[192:195], v[168:171], v[24:27]
    buffer_load_dwordx4 v[136:139], v241, s[40:43], s63 offen offset:1024 sc1
    v_mfma_f32_16x16x32_bf16 v[28:31], v[196:199], v[168:171], v[28:31]
    v_mfma_f32_16x16x32_bf16 v[32:35], v[200:203], v[168:171], v[32:35]
    buffer_load_dwordx4 v[140:143], v242, s[40:43], s63 offen offset:1024 sc1
    v_mfma_f32_16x16x32_bf16 v[36:39], v[184:187], v[172:175], v[36:39]
    v_mfma_f32_16x16x32_bf16 v[40:43], v[188:191], v[172:175], v[40:43]
    buffer_load_dwordx4 v[144:147], v243, s[40:43], s63 offen offset:1024 sc1
    v_mfma_f32_16x16x32_bf16 v[44:47], v[192:195], v[172:175], v[44:47]
    v_mfma_f32_16x16x32_bf16 v[48:51], v[196:199], v[172:175], v[48:51]
    buffer_load_dwordx4 v[148:151], v244, s[44:47], s63 offen offset:1024 sc1
    v_mfma_f32_16x16x32_bf16 v[52:55], v[200:203], v[172:175], v[52:55]
    v_mfma_f32_16x16x32_bf16 v[56:59], v[184:187], v[176:179], v[56:59]
    buffer_load_dwordx4 v[152:155], v245, s[44:47], s63 offen offset:1024 sc1
    v_mfma_f32_16x16x32_bf16 v[60:63], v[188:191], v[176:179], v[60:63]
    v_mfma_f32_16x16x32_bf16 v[64:67], v[192:195], v[176:179], v[64:67]
    buffer_load_dwordx4 v[156:159], v246, s[44:47], s63 offen offset:1024 sc1
    v_mfma_f32_16x16x32_bf16 v[68:71], v[196:199], v[176:179], v[68:71]
    v_mfma_f32_16x16x32_bf16 v[72:75], v[200:203], v[176:179], v[72:75]
    buffer_load_dwordx4 v[160:163], v247, s[44:47], s63 offen offset:1024 sc1
    v_mfma_f32_16x16x32_bf16 v[76:79], v[184:187], v[180:183], v[76:79]
    v_mfma_f32_16x16x32_bf16 v[80:83], v[188:191], v[180:183], v[80:83]
    buffer_load_dwordx4 v[164:167], v248, s[44:47], s63 offen offset:1024 sc1
    v_mfma_f32_16x16x32_bf16 v[84:87], v[192:195], v[180:183], v[84:87]
    v_mfma_f32_16x16x32_bf16 v[88:91], v[196:199], v[180:183], v[88:91]
    v_mfma_f32_16x16x32_bf16 v[92:95], v[200:203], v[180:183], v[92:95]
    s_waitcnt vmcnt(18)
    v_mfma_f32_16x16x32_bf16 v[16:19], v[220:223], v[204:207], v[16:19]
    buffer_load_dwordx4 v[168:171], v240, s[40:43], s63 offen offset:2048 sc1
    v_mfma_f32_16x16x32_bf16 v[20:23], v[224:227], v[204:207], v[20:23]
    v_mfma_f32_16x16x32_bf16 v[24:27], v[228:231], v[204:207], v[24:27]
    buffer_load_dwordx4 v[172:175], v241, s[40:43], s63 offen offset:2048 sc1
    v_mfma_f32_16x16x32_bf16 v[28:31], v[232:235], v[204:207], v[28:31]
    v_mfma_f32_16x16x32_bf16 v[32:35], v[236:239], v[204:207], v[32:35]
    buffer_load_dwordx4 v[176:179], v242, s[40:43], s63 offen offset:2048 sc1
    v_mfma_f32_16x16x32_bf16 v[36:39], v[220:223], v[208:211], v[36:39]
    v_mfma_f32_16x16x32_bf16 v[40:43], v[224:227], v[208:211], v[40:43]
    buffer_load_dwordx4 v[180:183], v243, s[40:43], s63 offen offset:2048 sc1
    v_mfma_f32_16x16x32_bf16 v[44:47], v[228:231], v[208:211], v[44:47]
    v_mfma_f32_16x16x32_bf16 v[48:51], v[232:235], v[208:211], v[48:51]
    buffer_load_dwordx4 v[184:187], v244, s[44:47], s63 offen offset:2048 sc1
    v_mfma_f32_16x16x32_bf16 v[52:55], v[236:239], v[208:211], v[52:55]
    v_mfma_f32_16x16x32_bf16 v[56:59], v[220:223], v[212:215], v[56:59]
    buffer_load_dwordx4 v[188:191], v245, s[44:47], s63 offen offset:2048 sc1
    v_mfma_f32_16x16x32_bf16 v[60:63], v[224:227], v[212:215], v[60:63]
    v_mfma_f32_16x16x32_bf16 v[64:67], v[228:231], v[212:215], v[64:67]
    buffer_load_dwordx4 v[192:195], v246, s[44:47], s63 offen offset:2048 sc1
    v_mfma_f32_16x16x32_bf16 v[68:71], v[232:235], v[212:215], v[68:71]
    v_mfma_f32_16x16x32_bf16 v[72:75], v[236:239], v[212:215], v[72:75]
    buffer_load_dwordx4 v[196:199], v247, s[44:47], s63 offen offset:2048 sc1
    v_mfma_f32_16x16x32_bf16 v[76:79], v[220:223], v[216:219], v[76:79]
    v_mfma_f32_16x16x32_bf16 v[80:83], v[224:227], v[216:219], v[80:83]
    buffer_load_dwordx4 v[200:203], v248, s[44:47], s63 offen offset:2048 sc1
    v_mfma_f32_16x16x32_bf16 v[84:87], v[228:231], v[216:219], v[84:87]
    v_mfma_f32_16x16x32_bf16 v[88:91], v[232:235], v[216:219], v[88:91]
    v_mfma_f32_16x16x32_bf16 v[92:95], v[236:239], v[216:219], v[92:95]
    s_waitcnt vmcnt(18)
    v_mfma_f32_16x16x32_bf16 v[16:19], v[112:115], v[96:99], v[16:19]
    buffer_load_dwordx4 v[204:207], v240, s[40:43], s63 offen offset:3072 sc1
    v_mfma_f32_16x16x32_bf16 v[20:23], v[116:119], v[96:99], v[20:23]
    v_mfma_f32_16x16x32_bf16 v[24:27], v[120:123], v[96:99], v[24:27]
    buffer_load_dwordx4 v[208:211], v241, s[40:43], s63 offen offset:3072 sc1
    v_mfma_f32_16x16x32_bf16 v[28:31], v[124:127], v[96:99], v[28:31]
    v_mfma_f32_16x16x32_bf16 v[32:35], v[128:131], v[96:99], v[32:35]
    buffer_load_dwordx4 v[212:215], v242, s[40:43], s63 offen offset:3072 sc1
    v_mfma_f32_16x16x32_bf16 v[36:39], v[112:115], v[100:103], v[36:39]
    v_mfma_f32_16x16x32_bf16 v[40:43], v[116:119], v[100:103], v[40:43]
    buffer_load_dwordx4 v[216:219], v243, s[40:43], s63 offen offset:3072 sc1
    v_mfma_f32_16x16x32_bf16 v[44:47], v[120:123], v[100:103], v[44:47]
    v_mfma_f32_16x16x32_bf16 v[48:51], v[124:127], v[100:103], v[48:51]
    buffer_load_dwordx4 v[220:223], v244, s[44:47], s63 offen offset:3072 sc1
    v_mfma_f32_16x16x32_bf16 v[52:55], v[128:131], v[100:103], v[52:55]
    v_mfma_f32_16x16x32_bf16 v[56:59], v[112:115], v[104:107], v[56:59]
    buffer_load_dwordx4 v[224:227], v245, s[44:47], s63 offen offset:3072 sc1
    v_mfma_f32_16x16x32_bf16 v[60:63], v[116:119], v[104:107], v[60:63]
    v_mfma_f32_16x16x32_bf16 v[64:67], v[120:123], v[104:107], v[64:67]
    buffer_load_dwordx4 v[228:231], v246, s[44:47], s63 offen offset:3072 sc1
    v_mfma_f32_16x16x32_bf16 v[68:71], v[124:127], v[104:107], v[68:71]
    v_mfma_f32_16x16x32_bf16 v[72:75], v[128:131], v[104:107], v[72:75]
    buffer_load_dwordx4 v[232:235], v247, s[44:47], s63 offen offset:3072 sc1
    v_mfma_f32_16x16x32_bf16 v[76:79], v[112:115], v[108:111], v[76:79]
    v_mfma_f32_16x16x32_bf16 v[80:83], v[116:119], v[108:111], v[80:83]
    buffer_load_dwordx4 v[236:239], v248, s[44:47], s63 offen offset:3072 sc1
    s_add_u32 s63, s63, 4096
    v_mfma_f32_16x16x32_bf16 v[84:87], v[120:123], v[108:111], v[84:87]
    v_mfma_f32_16x16x32_bf16 v[88:91], v[124:127], v[108:111], v[88:91]
    v_mfma_f32_16x16x32_bf16 v[92:95], v[128:131], v[108:111], v[92:95]
    s_waitcnt vmcnt(18)
    v_mfma_f32_16x16x32_bf16 v[16:19], v[148:151], v[132:135], v[16:19]
    buffer_load_dwordx4 v[96:99], v240, s[40:43], s63 offen offset:0 sc1
    v_mfma_f32_16x16x32_bf16 v[20:23], v[152:155], v[132:135], v[20:23]
    v_mfma_f32_16x16x32_bf16 v[24:27], v[156:159], v[132:135], v[24:27]
    buffer_load_dwordx4 v[100:103], v241, s[40:43], s63 offen offset:0 sc1
    v_mfma_f32_16x16x32_bf16 v[28:31], v[160:163], v[132:135], v[28:31]
    v_mfma_f32_16x16x32_bf16 v[32:35], v[164:167], v[132:135], v[32:35]
    buffer_load_dwordx4 v[104:107], v242, s[40:43], s63 offen offset:0 sc1
    v_mfma_f32_16x16x32_bf16 v[36:39], v[148:151], v[136:139], v[36:39]
    v_mfma_f32_16x16x32_bf16 v[40:43], v[152:155], v[136:139], v[40:43]
    buffer_load_dwordx4 v[108:111], v243, s[40:43], s63 offen offset:0 sc1
    v_mfma_f32_16x16x32_bf16 v[44:47], v[156:159], v[136:139], v[44:47]
    v_mfma_f32_16x16x32_bf16 v[48:51], v[160:163], v[136:139], v[48:51]
    ds_read_b64_tr_b16 v[112:113], v253 offset:0
    ds_read_b64_tr_b16 v[114:115], v253 offset:1280
    v_mfma_f32_16x16x32_bf16 v[52:55], v[164:167], v[136:139], v[52:55]
    v_mfma_f32_16x16x32_bf16 v[56:59], v[148:151], v[140:143], v[56:59]
    ds_read_b64_tr_b16 v[116:117], v253 offset:32
    ds_read_b64_tr_b16 v[118:119], v253 offset:1312
    v_mfma_f32_16x16x32_bf16 v[60:63], v[152:155], v[140:143], v[60:63]
    v_mfma_f32_16x16x32_bf16 v[64:67], v[156:159], v[140:143], v[64:67]
    ds_read_b64_tr_b16 v[120:121], v253 offset:64
    ds_read_b64_tr_b16 v[122:123], v253 offset:1344
    v_mfma_f32_16x16x32_bf16 v[68:71], v[160:163], v[140:143], v[68:71]
    v_mfma_f32_16x16x32_bf16 v[72:75], v[164:167], v[140:143], v[72:75]
    ds_read_b64_tr_b16 v[124:125], v253 offset:96
    ds_read_b64_tr_b16 v[126:127], v253 offset:1376
    v_mfma_f32_16x16x32_bf16 v[76:79], v[148:151], v[144:147], v[76:79]
    v_mfma_f32_16x16x32_bf16 v[80:83], v[152:155], v[144:147], v[80:83]
    ds_read_b64_tr_b16 v[128:129], v253 offset:128
    ds_read_b64_tr_b16 v[130:131], v253 offset:1408
    v_mfma_f32_16x16x32_bf16 v[84:87], v[156:159], v[144:147], v[84:87]
    v_mfma_f32_16x16x32_bf16 v[88:91], v[160:163], v[144:147], v[88:91]
    v_mfma_f32_16x16x32_bf16 v[92:95], v[164:167], v[144:147], v[92:95]
    s_waitcnt vmcnt(13)
    v_mfma_f32_16x16x32_bf16 v[16:19], v[184:187], v[168:171], v[16:19]
    buffer_load_dwordx4 v[132:135], v240, s[40:43], s63 offen offset:1024 sc1
    v_mfma_f32_16x16x32_bf16 v[20:23], v[188:191], v[168:171], v[20:23]
    v_mfma_f32_16x16x32_bf16 v[24:27], v[192:195], v[168:171], v[24:27]
    buffer_load_dwordx4 v[136:139], v241, s[40:43], s63 offen offset:1024 sc1
    v_mfma_f32_16x16x32_bf16 v[28:31], v[196:199], v[168:171], v[28:31]
    v_mfma_f32_16x16x32_bf16 v[32:35], v[200:203], v[168:171], v[32:35]
    buffer_load_dwordx4 v[140:143], v242, s[40:43], s63 offen offset:1024 sc1
    v_mfma_f32_16x16x32_bf16 v[36:39], v[184:187], v[172:175], v[36:39]
    v_mfma_f32_16x16x32_bf16 v[40:43], v[188:191], v[172:175], v[40:43]
    buffer_load_dwordx4 v[144:147], v243, s[40:43], s63 offen offset:1024 sc1
    v_mfma_f32_16x16x32_bf16 v[44:47], v[192:195], v[172:175], v[44:47]
    v_mfma_f32_16x16x32_bf16 v[48:51], v[196:199], v[172:175], v[48:51]
    ds_read_b64_tr_b16 v[148:149], v253 offset:5120
    ds_read_b64_tr_b16 v[150:151], v253 offset:6400
    v_mfma_f32_16x16x32_bf16 v[52:55], v[200:203], v[172:175], v[52:55]
    v_mfma_f32_16x16x32_bf16 v[56:59], v[184:187], v[176:179], v[56:59]
    ds_read_b64_tr_b16 v[152:153], v253 offset:5152
    ds_read_b64_tr_b16 v[154:155], v253 offset:6432
    v_mfma_f32_16x16x32_bf16 v[60:63], v[188:191], v[176:179], v[60:63]
    v_mfma_f32_16x16x32_bf16 v[64:67], v[192:195], v[176:179], v[64:67]
    ds_read_b64_tr_b16 v[156:157], v253 offset:5184
    ds_read_b64_tr_b16 v[158:159], v253 offset:6464
    v_mfma_f32_16x16x32_bf16 v[68:71], v[196:199], v[176:179], v[68:71]
    v_mfma_f32_16x16x32_bf16 v[72:75], v[200:203], v[176:179], v[72:75]
    ds_read_b64_tr_b16 v[160:161], v253 offset:5216
    ds_read_b64_tr_b16 v[162:163], v253 offset:6496
    v_mfma_f32_16x16x32_bf16 v[76:79], v[184:187], v[180:183], v[76:79]
    v_mfma_f32_16x16x32_bf16 v[80:83], v[188:191], v[180:183], v[80:83]
    ds_read_b64_tr_b16 v[164:165], v253 offset:5248
    ds_read_b64_tr_b16 v[166:167], v253 offset:6528
    v_mfma_f32_16x16x32_bf16 v[84:87], v[192:195], v[180:183], v[84:87]
    v_mfma_f32_16x16x32_bf16 v[88:91], v[196:199], v[180:183], v[88:91]
    v_mfma_f32_16x16x32_bf16 v[92:95], v[200:203], v[180:183], v[92:95]
    s_waitcnt vmcnt(8)
    v_mfma_f32_16x16x32_bf16 v[16:19], v[220:223], v[204:207], v[16:19]
    buffer_load_dwordx4 v[168:171], v240, s[40:43], s63 offen offset:2048 sc1
    v_mfma_f32_16x16x32_bf16 v[20:23], v[224:227], v[204:207], v[20:23]
    v_mfma_f32_16x16x32_bf16 v[24:27], v[228:231], v[204:207], v[24:27]
    buffer_load_dwordx4 v[172:175], v241, s[40:43], s63 offen offset:2048 sc1
    v_mfma_f32_16x16x32_bf16 v[28:31], v[232:235], v[204:207], v[28:31]
    v_mfma_f32_16x16x32_bf16 v[32:35], v[236:239], v[204:207], v[32:35]
    buffer_load_dwordx4 v[176:179], v242, s[40:43], s63 offen offset:2048 sc1
    v_mfma_f32_16x16x32_bf16 v[36:39], v[220:223], v[208:211], v[36:39]
    v_mfma_f32_16x16x32_bf16 v[40:43], v[224:227], v[208:211], v[40:43]
    buffer_load_dwordx4 v[180:183], v243, s[40:43], s63 offen offset:2048 sc1
    v_mfma_f32_16x16x32_bf16 v[44:47], v[228:231], v[208:211], v[44:47]
    v_mfma_f32_16x16x32_bf16 v[48:51], v[232:235], v[208:211], v[48:51]
    ds_read_b64_tr_b16 v[184:185], v253 offset:10240
    ds_read_b64_tr_b16 v[186:187], v253 offset:11520
    v_mfma_f32_16x16x32_bf16 v[52:55], v[236:239], v[208:211], v[52:55]
    v_mfma_f32_16x16x32_bf16 v[56:59], v[220:223], v[212:215], v[56:59]
    ds_read_b64_tr_b16 v[188:189], v253 offset:10272
    ds_read_b64_tr_b16 v[190:191], v253 offset:11552
    v_mfma_f32_16x16x32_bf16 v[60:63], v[224:227], v[212:215], v[60:63]
    v_mfma_f32_16x16x32_bf16 v[64:67], v[228:231], v[212:215], v[64:67]
    ds_read_b64_tr_b16 v[192:193], v253 offset:10304
    ds_read_b64_tr_b16 v[194:195], v253 offset:11584
    v_mfma_f32_16x16x32_bf16 v[68:71], v[232:235], v[212:215], v[68:71]
    v_mfma_f32_16x16x32_bf16 v[72:75], v[236:239], v[212:215], v[72:75]
    ds_read_b64_tr_b16 v[196:197], v253 offset:10336
    ds_read_b64_tr_b16 v[198:199], v253 offset:11616
    v_mfma_f32_16x16x32_bf16 v[76:79], v[220:223], v[216:219], v[76:79]
    v_mfma_f32_16x16x32_bf16 v[80:83], v[224:227], v[216:219], v[80:83]
    ds_read_b64_tr_b16 v[200:201], v253 offset:10368
    ds_read_b64_tr_b16 v[202:203], v253 offset:11648
    v_mfma_f32_16x16x32_bf16 v[84:87], v[228:231], v[216:219], v[84:87]
    v_mfma_f32_16x16x32_bf16 v[88:91], v[232:235], v[216:219], v[88:91]
    v_mfma_f32_16x16x32_bf16 v[92:95], v[236:239], v[216:219], v[92:95]
    s_waitcnt vmcnt(8)
    s_waitcnt lgkmcnt(15)
    v_mfma_f32_16x16x32_bf16 v[16:19], v[112:115], v[96:99], v[16:19]
    buffer_load_dwordx4 v[204:207], v240, s[40:43], s63 offen offset:3072 sc1
    v_mfma_f32_16x16x32_bf16 v[20:23], v[116:119], v[96:99], v[20:23]
    v_mfma_f32_16x16x32_bf16 v[24:27], v[120:123], v[96:99], v[24:27]
    buffer_load_dwordx4 v[208:211], v241, s[40:43], s63 offen offset:3072 sc1
    v_mfma_f32_16x16x32_bf16 v[28:31], v[124:127], v[96:99], v[28:31]
    v_mfma_f32_16x16x32_bf16 v[32:35], v[128:131], v[96:99], v[32:35]
    buffer_load_dwordx4 v[212:215], v242, s[40:43], s63 offen offset:3072 sc1
    v_mfma_f32_16x16x32_bf16 v[36:39], v[112:115], v[100:103], v[36:39]
    v_mfma_f32_16x16x32_bf16 v[40:43], v[116:119], v[100:103], v[40:43]
    buffer_load_dwordx4 v[216:219], v243, s[40:43], s63 offen offset:3072 sc1
    v_mfma_f32_16x16x32_bf16 v[44:47], v[120:123], v[100:103], v[44:47]
    v_mfma_f32_16x16x32_bf16 v[48:51], v[124:127], v[100:103], v[48:51]
    ds_read_b64_tr_b16 v[220:221], v253 offset:15360
    ds_read_b64_tr_b16 v[222:223], v253 offset:16640
    v_mfma_f32_16x16x32_bf16 v[52:55], v[128:131], v[100:103], v[52:55]
    v_mfma_f32_16x16x32_bf16 v[56:59], v[112:115], v[104:107], v[56:59]
    ds_read_b64_tr_b16 v[224:225], v253 offset:15392
    ds_read_b64_tr_b16 v[226:227], v253 offset:16672
    v_mfma_f32_16x16x32_bf16 v[60:63], v[116:119], v[104:107], v[60:63]
    v_mfma_f32_16x16x32_bf16 v[64:67], v[120:123], v[104:107], v[64:67]
    ds_read_b64_tr_b16 v[228:229], v253 offset:15424
    ds_read_b64_tr_b16 v[230:231], v253 offset:16704
    v_mfma_f32_16x16x32_bf16 v[68:71], v[124:127], v[104:107], v[68:71]
    v_mfma_f32_16x16x32_bf16 v[72:75], v[128:131], v[104:107], v[72:75]
    ds_read_b64_tr_b16 v[232:233], v253 offset:15456
    ds_read_b64_tr_b16 v[234:235], v253 offset:16736
    v_mfma_f32_16x16x32_bf16 v[76:79], v[112:115], v[108:111], v[76:79]
    v_mfma_f32_16x16x32_bf16 v[80:83], v[116:119], v[108:111], v[80:83]
    ds_read_b64_tr_b16 v[236:237], v253 offset:15488
    ds_read_b64_tr_b16 v[238:239], v253 offset:16768
    s_add_u32 s63, s63, 4096
    v_mfma_f32_16x16x32_bf16 v[84:87], v[120:123], v[108:111], v[84:87]
    v_mfma_f32_16x16x32_bf16 v[88:91], v[124:127], v[108:111], v[88:91]
    v_mfma_f32_16x16x32_bf16 v[92:95], v[128:131], v[108:111], v[92:95]
    s_waitcnt vmcnt(8)
    s_waitcnt lgkmcnt(15)
    v_mfma_f32_16x16x32_bf16 v[16:19], v[148:151], v[132:135], v[16:19]
    v_mfma_f32_16x16x32_bf16 v[20:23], v[152:155], v[132:135], v[20:23]
    v_mfma_f32_16x16x32_bf16 v[24:27], v[156:159], v[132:135], v[24:27]
    v_mfma_f32_16x16x32_bf16 v[28:31], v[160:163], v[132:135], v[28:31]
    v_mfma_f32_16x16x32_bf16 v[32:35], v[164:167], v[132:135], v[32:35]
    v_mfma_f32_16x16x32_bf16 v[36:39], v[148:151], v[136:139], v[36:39]
    v_mfma_f32_16x16x32_bf16 v[40:43], v[152:155], v[136:139], v[40:43]
    v_mfma_f32_16x16x32_bf16 v[44:47], v[156:159], v[136:139], v[44:47]
    v_mfma_f32_16x16x32_bf16 v[48:51], v[160:163], v[136:139], v[48:51]
    v_mfma_f32_16x16x32_bf16 v[52:55], v[164:167], v[136:139], v[52:55]
    v_mfma_f32_16x16x32_bf16 v[56:59], v[148:151], v[140:143], v[56:59]
    v_mfma_f32_16x16x32_bf16 v[60:63], v[152:155], v[140:143], v[60:63]
    v_mfma_f32_16x16x32_bf16 v[64:67], v[156:159], v[140:143], v[64:67]
    v_mfma_f32_16x16x32_bf16 v[68:71], v[160:163], v[140:143], v[68:71]
    v_mfma_f32_16x16x32_bf16 v[72:75], v[164:167], v[140:143], v[72:75]
    v_mfma_f32_16x16x32_bf16 v[76:79], v[148:151], v[144:147], v[76:79]
    v_mfma_f32_16x16x32_bf16 v[80:83], v[152:155], v[144:147], v[80:83]
    v_mfma_f32_16x16x32_bf16 v[84:87], v[156:159], v[144:147], v[84:87]
    v_mfma_f32_16x16x32_bf16 v[88:91], v[160:163], v[144:147], v[88:91]
    v_mfma_f32_16x16x32_bf16 v[92:95], v[164:167], v[144:147], v[92:95]
    s_waitcnt vmcnt(4)
    s_waitcnt lgkmcnt(10)
    v_mfma_f32_16x16x32_bf16 v[16:19], v[184:187], v[168:171], v[16:19]
    v_mfma_f32_16x16x32_bf16 v[20:23], v[188:191], v[168:171], v[20:23]
    v_mfma_f32_16x16x32_bf16 v[24:27], v[192:195], v[168:171], v[24:27]
    v_mfma_f32_16x16x32_bf16 v[28:31], v[196:199], v[168:171], v[28:31]
    v_mfma_f32_16x16x32_bf16 v[32:35], v[200:203], v[168:171], v[32:35]
    v_mfma_f32_16x16x32_bf16 v[36:39], v[184:187], v[172:175], v[36:39]
    v_mfma_f32_16x16x32_bf16 v[40:43], v[188:191], v[172:175], v[40:43]
    v_mfma_f32_16x16x32_bf16 v[44:47], v[192:195], v[172:175], v[44:47]
    v_mfma_f32_16x16x32_bf16 v[48:51], v[196:199], v[172:175], v[48:51]
    v_mfma_f32_16x16x32_bf16 v[52:55], v[200:203], v[172:175], v[52:55]
    v_mfma_f32_16x16x32_bf16 v[56:59], v[184:187], v[176:179], v[56:59]
    v_mfma_f32_16x16x32_bf16 v[60:63], v[188:191], v[176:179], v[60:63]
    v_mfma_f32_16x16x32_bf16 v[64:67], v[192:195], v[176:179], v[64:67]
    v_mfma_f32_16x16x32_bf16 v[68:71], v[196:199], v[176:179], v[68:71]
    v_mfma_f32_16x16x32_bf16 v[72:75], v[200:203], v[176:179], v[72:75]
    v_mfma_f32_16x16x32_bf16 v[76:79], v[184:187], v[180:183], v[76:79]
    v_mfma_f32_16x16x32_bf16 v[80:83], v[188:191], v[180:183], v[80:83]
    v_mfma_f32_16x16x32_bf16 v[84:87], v[192:195], v[180:183], v[84:87]
    v_mfma_f32_16x16x32_bf16 v[88:91], v[196:199], v[180:183], v[88:91]
    v_mfma_f32_16x16x32_bf16 v[92:95], v[200:203], v[180:183], v[92:95]
    s_waitcnt vmcnt(0)
    s_waitcnt lgkmcnt(0)
    v_mov_b32 v4, 161188
    s_mov_b32 s39, 0
L_kf_kernel_Gw1:
    ds_read_b32 v5, v4
    s_waitcnt lgkmcnt(0)
    v_readfirstlane_b32 s36, v5
    s_add_u32 s39, s39, 1
    s_cmp_eq_u32 s36, 8
    s_cbranch_scc1 L_kf_kernel_Gw1d
    s_sleep 1
    s_cmp_lt_u32 s39, 0x400000
    s_cbranch_scc1 L_kf_kernel_Gw1
L_kf_kernel_Gw1d:
    v_mfma_f32_16x16x32_bf16 v[36:39], v[220:223], v[208:211], v[36:39]
    v_mfma_f32_16x16x32_bf16 v[40:43], v[224:227], v[208:211], v[40:43]
    v_mfma_f32_16x16x32_bf16 v[44:47], v[228:231], v[208:211], v[44:47]
    v_mfma_f32_16x16x32_bf16 v[48:51], v[232:235], v[208:211], v[48:51]
    v_mfma_f32_16x16x32_bf16 v[52:55], v[236:239], v[208:211], v[52:55]
    v_mfma_f32_16x16x32_bf16 v[56:59], v[220:223], v[212:215], v[56:59]
    v_mfma_f32_16x16x32_bf16 v[60:63], v[224:227], v[212:215], v[60:63]
    v_mfma_f32_16x16x32_bf16 v[64:67], v[228:231], v[212:215], v[64:67]
    s_nop 0
    ds_write_b128 v252, v[36:39] offset:0
    v_mfma_f32_16x16x32_bf16 v[68:71], v[232:235], v[212:215], v[68:71]
    ds_write_b128 v252, v[40:43] offset:1024
    v_mfma_f32_16x16x32_bf16 v[72:75], v[236:239], v[212:215], v[72:75]
    ds_write_b128 v252, v[44:47] offset:2048
    v_mfma_f32_16x16x32_bf16 v[76:79], v[220:223], v[216:219], v[76:79]
    ds_write_b128 v252, v[48:51] offset:3072
    v_mfma_f32_16x16x32_bf16 v[80:83], v[224:227], v[216:219], v[80:83]
    ds_write_b128 v252, v[52:55] offset:4096
    v_mfma_f32_16x16x32_bf16 v[84:87], v[228:231], v[216:219], v[84:87]
    ds_write_b128 v252, v[56:59] offset:5120
    v_mfma_f32_16x16x32_bf16 v[88:91], v[232:235], v[216:219], v[88:91]
    ds_write_b128 v252, v[60:63] offset:6144
    v_mfma_f32_16x16x32_bf16 v[92:95], v[236:239], v[216:219], v[92:95]
    ds_write_b128 v252, v[64:67] offset:7168
    v_mfma_f32_16x16x32_bf16 v[16:19], v[220:223], v[204:207], v[16:19]
    ds_write_b128 v252, v[68:71] offset:8192
    v_mfma_f32_16x16x32_bf16 v[20:23], v[224:227], v[204:207], v[20:23]
    ds_write_b128 v252, v[72:75] offset:9216
    v_mfma_f32_16x16x32_bf16 v[24:27], v[228:231], v[204:207], v[24:27]
    ds_write_b128 v252, v[76:79] offset:10240
    v_mfma_f32_16x16x32_bf16 v[28:31], v[232:235], v[204:207], v[28:31]
    ds_write_b128 v252, v[80:83] offset:11264
    v_mfma_f32_16x16x32_bf16 v[32:35], v[236:239], v[204:207], v[32:35]
    ds_write_b128 v252, v[84:87] offset:12288
    ds_write_b128 v252, v[88:91] offset:13312
    ds_write_b128 v252, v[92:95] offset:14336
    v_mov_b32 v4, 161200
    v_mov_b32 v5, 1
    s_mov_b64 exec, 1
    ds_add_u32 v4, v5
    s_mov_b64 exec, -1
    s_add_u32 s36, s35, 1
    s_and_b32 s36, s36, 3
    s_mul_i32 s36, s36, 23552
    s_add_u32 s36, s36, 71680
    v_add_u32 v7, s36, v2
    s_add_u32 s36, s35, 2
    s_and_b32 s36, s36, 3
    s_mul_i32 s36, s36, 23552
    s_add_u32 s36, s36, 66560
    v_add_u32 v8, s36, v2
    s_add_u32 s36, s35, 3
    s_and_b32 s36, s36, 3
    s_mul_i32 s36, s36, 23552
    s_add_u32 s36, s36, 61440
    v_add_u32 v9, s36, v2
    v_mov_b32 v4, 161200
    s_mov_b32 s39, 0
L_kf_kernel_Gw2:
    ds_read_b32 v5, v4
    s_waitcnt lgkmcnt(0)
    v_readfirstlane_b32 s36, v5
    s_add_u32 s39, s39, 1
    s_cmp_eq_u32 s36, 4
    s_cbranch_scc1 L_kf_kernel_Gw2d
    s_sleep 1
    s_cmp_lt_u32 s39, 0x400000
    s_cbranch_scc1 L_kf_kernel_Gw2
L_kf_kernel_Gw2d:
    ds_read_b128 v[96:99], v7 offset:0
    ds_read_b128 v[100:103], v8 offset:0
    ds_read_b128 v[104:107], v9 offset:0
    ds_read_b128 v[108:111], v7 offset:1024
    ds_read_b128 v[112:115], v8 offset:1024
    ds_read_b128 v[116:119], v9 offset:1024
    ds_read_b128 v[120:123], v7 offset:2048
    ds_read_b128 v[124:127], v8 offset:2048
    ds_read_b128 v[128:131], v9 offset:2048
    ds_read_b128 v[132:135], v7 offset:3072
    ds_read_b128 v[136:139], v8 offset:3072
    ds_read_b128 v[140:143], v9 offset:3072
    ds_read_b128 v[144:147], v7 offset:4096
    ds_read_b128 v[148:151], v8 offset:4096
    ds_read_b128 v[152:155], v9 offset:4096
    v_lshlrev_b32 v10, 3, v1
    v_add_u32 v10, s67, v10
    v_mul_u32_u24 v11, 160, v3
    v_add_u32 v11, v11, v10
    ds_read_b64 v[38:39], v10 offset:2560
    ds_read_b64 v[78:79], v10 offset:2720
    ds_read_b64 v[58:59], v11 offset:0
    ds_read_b64 v[42:43], v10 offset:2592
    ds_read_b64 v[82:83], v10 offset:2752
    ds_read_b64 v[62:63], v11 offset:32
    ds_read_b64 v[46:47], v10 offset:2624
    ds_read_b64 v[86:87], v10 offset:2784
    ds_read_b64 v[66:67], v11 offset:64
    ds_read_b64 v[50:51], v10 offset:2656
    ds_read_b64 v[90:91], v10 offset:2816
    ds_read_b64 v[70:71], v11 offset:96
    ds_read_b64 v[54:55], v10 offset:2688
    ds_read_b64 v[94:95], v10 offset:2848
    ds_read_b64 v[74:75], v11 offset:128
    s_waitcnt lgkmcnt(15)
    v_add_f32 v16, v16, v96
    v_add_f32 v17, v17, v97
    v_add_f32 v18, v18, v98
    v_add_f32 v19, v19, v99
    v_add_f32 v100, v100, v104
    v_add_f32 v101, v101, v105
    v_add_f32 v102, v102, v106
    v_add_f32 v103, v103, v107
    v_add_f32 v16, v16, v100
    v_add_f32 v17, v17, v101
    v_add_f32 v18, v18, v102
    v_add_f32 v19, v19, v103
    v_add_f32 v20, v20, v108
    v_add_f32 v21, v21, v109
    v_add_f32 v22, v22, v110
    v_add_f32 v23, v23, v111
    v_add_f32 v112, v112, v116
    v_add_f32 v113, v113, v117
    v_add_f32 v114, v114, v118
    v_add_f32 v115, v115, v119
    v_add_f32 v20, v20, v112
    v_add_f32 v21, v21, v113
    v_add_f32 v22, v22, v114
    v_add_f32 v23, v23, v115
    v_add_f32 v24, v24, v120
    v_add_f32 v25, v25, v121
    v_add_f32 v26, v26, v122
    v_add_f32 v27, v27, v123
    v_add_f32 v124, v124, v128
    v_add_f32 v125, v125, v129
    v_add_f32 v126, v126, v130
    v_add_f32 v127, v127, v131
    v_add_f32 v24, v24, v124
    v_add_f32 v25, v25, v125
    v_add_f32 v26, v26, v126
    v_add_f32 v27, v27, v127
    v_add_f32 v28, v28, v132
    v_add_f32 v29, v29, v133
    v_add_f32 v30, v30, v134
    v_add_f32 v31, v31, v135
    v_add_f32 v136, v136, v140
    v_add_f32 v137, v137, v141
    v_add_f32 v138, v138, v142
    v_add_f32 v139, v139, v143
    v_add_f32 v28, v28, v136
    v_add_f32 v29, v29, v137
    v_add_f32 v30, v30, v138
    v_add_f32 v31, v31, v139
    v_add_f32 v32, v32, v144
    v_add_f32 v33, v33, v145
    v_add_f32 v34, v34, v146
    v_add_f32 v35, v35, v147
    v_add_f32 v148, v148, v152
    v_add_f32 v149, v149, v153
    v_add_f32 v150, v150, v154
    v_add_f32 v151, v151, v155
    v_add_f32 v32, v32, v148
    v_add_f32 v33, v33, v149
    v_add_f32 v34, v34, v150
    v_add_f32 v35, v35, v151
    s_waitcnt lgkmcnt(0)
    v_mov_b32 v4, 161204
    v_mov_b32 v5, 1
    s_mov_b64 exec, 1
    ds_add_u32 v4, v5
    s_mov_b64 exec, -1
    s_mov_b32 s36, 0xffff0000
    s_mov_b32 s37, 3216550459
    v_lshlrev_b32 v36, 16, v38
    v_and_b32 v37, s36, v38
    v_lshlrev_b32 v38, 16, v39
    v_and_b32 v39, s36, v39
    v_lshlrev_b32 v40, 16, v42
    v_and_b32 v41, s36, v42
    v_lshlrev_b32 v42, 16, v43
    v_and_b32 v43, s36, v43
    v_lshlrev_b32 v44, 16, v46
    v_and_b32 v45, s36, v46
    v_lshlrev_b32 v46, 16, v47
    v_and_b32 v47, s36, v47
    v_lshlrev_b32 v48, 16, v50
    v_and_b32 v49, s36, v50
    v_lshlrev_b32 v50, 16, v51
    v_and_b32 v51, s36, v51
    v_lshlrev_b32 v52, 16, v54
    v_and_b32 v53, s36, v54
    v_lshlrev_b32 v54, 16, v55
    v_and_b32 v55, s36, v55
    v_lshlrev_b32 v56, 16, v58
    v_and_b32 v57, s36, v58
    v_lshlrev_b32 v58, 16, v59
    v_and_b32 v59, s36, v59
    v_lshlrev_b32 v60, 16, v62
    v_and_b32 v61, s36, v62
    v_lshlrev_b32 v62, 16, v63
    v_and_b32 v63, s36, v63
    v_lshlrev_b32 v64, 16, v66
    v_and_b32 v65, s36, v66
    v_lshlrev_b32 v66, 16, v67
    v_and_b32 v67, s36, v67
    v_lshlrev_b32 v68, 16, v70
    v_and_b32 v69, s36, v70
    v_lshlrev_b32 v70, 16, v71
    v_and_b32 v71, s36, v71
    v_lshlrev_b32 v72, 16, v74
    v_and_b32 v73, s36, v74
    v_lshlrev_b32 v74, 16, v75
    v_and_b32 v75, s36, v75
    v_lshlrev_b32 v76, 16, v78
    v_and_b32 v77, s36, v78
    v_lshlrev_b32 v78, 16, v79
    v_and_b32 v79, s36, v79
    v_lshlrev_b32 v80, 16, v82
    v_and_b32 v81, s36, v82
    v_lshlrev_b32 v82, 16, v83
    v_and_b32 v83, s36, v83
    v_lshlrev_b32 v84, 16, v86
    v_and_b32 v85, s36, v86
    v_lshlrev_b32 v86, 16, v87
    v_and_b32 v87, s36, v87
    v_lshlrev_b32 v88, 16, v90
    v_and_b32 v89, s36, v90
    v_lshlrev_b32 v90, 16, v91
    v_and_b32 v91, s36, v91
    v_lshlrev_b32 v92, 16, v94
    v_and_b32 v93, s36, v94
    v_lshlrev_b32 v94, 16, v95
    v_and_b32 v95, s36, v95
    v_add_f32 v16, v16, v36
    v_add_f32 v17, v17, v37
    v_add_f32 v18, v18, v38
    v_add_f32 v19, v19, v39
    v_add_f32 v20, v20, v40
    v_add_f32 v21, v21, v41
    v_add_f32 v22, v22, v42
    v_add_f32 v23, v23, v43
    v_add_f32 v24, v24, v44
    v_add_f32 v25, v25, v45
    v_add_f32 v26, v26, v46
    v_add_f32 v27, v27, v47
    v_add_f32 v28, v28, v48
    v_add_f32 v29, v29, v49
    v_add_f32 v30, v30, v50
    v_add_f32 v31, v31, v51
    v_add_f32 v32, v32, v52
    v_add_f32 v33, v33, v53
    v_add_f32 v34, v34, v54
    v_add_f32 v35, v35, v55
    v_mul_f32 v36, s37, v16
    v_mul_f32 v37, s37, v17
    v_mul_f32 v38, s37, v18
    v_mul_f32 v39, s37, v19
    v_mul_f32 v40, s37, v20
    v_mul_f32 v41, s37, v21
    v_mul_f32 v42, s37, v22
    v_mul_f32 v43, s37, v23
    v_mul_f32 v44, s37, v24
    v_mul_f32 v45, s37, v25
    v_mul_f32 v46, s37, v26
    v_mul_f32 v47, s37, v27
    v_mul_f32 v48, s37, v28
    v_mul_f32 v49, s37, v29
    v_mul_f32 v50, s37, v30
    v_mul_f32 v51, s37, v31
    v_mul_f32 v52, s37, v32
    v_mul_f32 v53, s37, v33
    v_mul_f32 v54, s37, v34
    v_mul_f32 v55, s37, v35
    v_exp_f32 v36, v36
    v_exp_f32 v37, v37
    v_exp_f32 v38, v38
    v_exp_f32 v39, v39
    v_exp_f32 v40, v40
    v_exp_f32 v41, v41
    v_exp_f32 v42, v42
    v_exp_f32 v43, v43
    v_exp_f32 v44, v44
    v_exp_f32 v45, v45
    v_exp_f32 v46, v46
    v_exp_f32 v47, v47
    v_exp_f32 v48, v48
    v_exp_f32 v49, v49
    v_exp_f32 v50, v50
    v_exp_f32 v51, v51
    v_exp_f32 v52, v52
    v_exp_f32 v53, v53
    v_exp_f32 v54, v54
    v_exp_f32 v55, v55
    v_add_f32 v36, 1.0, v36
    v_add_f32 v37, 1.0, v37
    v_add_f32 v38, 1.0, v38
    v_add_f32 v39, 1.0, v39
    v_add_f32 v40, 1.0, v40
    v_add_f32 v41, 1.0, v41
    v_add_f32 v42, 1.0, v42
    v_add_f32 v43, 1.0, v43
    v_add_f32 v44, 1.0, v44
    v_add_f32 v45, 1.0, v45
    v_add_f32 v46, 1.0, v46
    v_add_f32 v47, 1.0, v47
    v_add_f32 v48, 1.0, v48
    v_add_f32 v49, 1.0, v49
    v_add_f32 v50, 1.0, v50
    v_add_f32 v51, 1.0, v51
    v_add_f32 v52, 1.0, v52
    v_add_f32 v53, 1.0, v53
    v_add_f32 v54, 1.0, v54
    v_add_f32 v55, 1.0, v55
    v_rcp_f32 v36, v36
    v_rcp_f32 v37, v37
    v_rcp_f32 v38, v38
    v_rcp_f32 v39, v39
    v_rcp_f32 v40, v40
    v_rcp_f32 v41, v41
    v_rcp_f32 v42, v42
    v_rcp_f32 v43, v43
    v_rcp_f32 v44, v44
    v_rcp_f32 v45, v45
    v_rcp_f32 v46, v46
    v_rcp_f32 v47, v47
    v_rcp_f32 v48, v48
    v_rcp_f32 v49, v49
    v_rcp_f32 v50, v50
    v_rcp_f32 v51, v51
    v_rcp_f32 v52, v52
    v_rcp_f32 v53, v53
    v_rcp_f32 v54, v54
    v_rcp_f32 v55, v55
    v_mul_f32 v16, v16, v36
    v_mul_f32 v17, v17, v37
    v_mul_f32 v18, v18, v38
    v_mul_f32 v19, v19, v39
    v_mul_f32 v20, v20, v40
    v_mul_f32 v21, v21, v41
    v_mul_f32 v22, v22, v42
    v_mul_f32 v23, v23, v43
    v_mul_f32 v24, v24, v44
    v_mul_f32 v25, v25, v45
    v_mul_f32 v26, v26, v46
    v_mul_f32 v27, v27, v47
    v_mul_f32 v28, v28, v48
    v_mul_f32 v29, v29, v49
    v_mul_f32 v30, v30, v50
    v_mul_f32 v31, v31, v51
    v_mul_f32 v32, v32, v52
    v_mul_f32 v33, v33, v53
    v_mul_f32 v34, v34, v54
    v_mul_f32 v35, v35, v55
    v_fma_f32 v36, v56, v251, -v250
    v_fma_f32 v37, v57, v251, -v250
    v_fma_f32 v38, v58, v251, -v250
    v_fma_f32 v39, v59, v251, -v250
    v_fma_f32 v40, v60, v251, -v250
    v_fma_f32 v41, v61, v251, -v250
    v_fma_f32 v42, v62, v251, -v250
    v_fma_f32 v43, v63, v251, -v250
    v_fma_f32 v44, v64, v251, -v250
    v_fma_f32 v45, v65, v251, -v250
    v_fma_f32 v46, v66, v251, -v250
    v_fma_f32 v47, v67, v251, -v250
    v_fma_f32 v48, v68, v251, -v250
    v_fma_f32 v49, v69, v251, -v250
    v_fma_f32 v50, v70, v251, -v250
    v_fma_f32 v51, v71, v251, -v250
    v_fma_f32 v52, v72, v251, -v250
    v_fma_f32 v53, v73, v251, -v250
    v_fma_f32 v54, v74, v251, -v250
    v_fma_f32 v55, v75, v251, -v250
    v_mul_f32 v76, v76, v16
    v_mul_f32 v77, v77, v17
    v_mul_f32 v78, v78, v18
    v_mul_f32 v79, v79, v19
    v_mul_f32 v80, v80, v20
    v_mul_f32 v81, v81, v21
    v_mul_f32 v82, v82, v22
    v_mul_f32 v83, v83, v23
    v_mul_f32 v84, v84, v24
    v_mul_f32 v85, v85, v25
    v_mul_f32 v86, v86, v26
    v_mul_f32 v87, v87, v27
    v_mul_f32 v88, v88, v28
    v_mul_f32 v89, v89, v29
    v_mul_f32 v90, v90, v30
    v_mul_f32 v91, v91, v31
    v_mul_f32 v92, v92, v32
    v_mul_f32 v93, v93, v33
    v_mul_f32 v94, v94, v34
    v_mul_f32 v95, v95, v35
    v_fmac_f32 v56, v36, v76
    v_fmac_f32 v57, v37, v77
    v_fmac_f32 v58, v38, v78
    v_fmac_f32 v59, v39, v79
    v_fmac_f32 v60, v40, v80
    v_fmac_f32 v61, v41, v81
    v_fmac_f32 v62, v42, v82
    v_fmac_f32 v63, v43, v83
    v_fmac_f32 v64, v44, v84
    v_fmac_f32 v65, v45, v85
    v_fmac_f32 v66, v46, v86
    v_fmac_f32 v67, v47, v87
    v_fmac_f32 v68, v48, v88
    v_fmac_f32 v69, v49, v89
    v_fmac_f32 v70, v50, v90
    v_fmac_f32 v71, v51, v91
    v_fmac_f32 v72, v52, v92
    v_fmac_f32 v73, v53, v93
    v_fmac_f32 v74, v54, v94
    v_fmac_f32 v75, v55, v95
    v_mov_b32 v4, 161204
    s_mov_b32 s39, 0
L_kf_kernel_Gw3:
    ds_read_b32 v5, v4
    s_waitcnt lgkmcnt(0)
    v_readfirstlane_b32 s36, v5
    s_add_u32 s39, s39, 1
    s_cmp_eq_u32 s36, 4
    s_cbranch_scc1 L_kf_kernel_Gw3d
    s_sleep 1
    s_cmp_lt_u32 s39, 0x400000
    s_cbranch_scc1 L_kf_kernel_Gw3
L_kf_kernel_Gw3d:
    ds_write_b128 v252, v[16:19] offset:0
    ds_write_b128 v252, v[56:59] offset:5120
    ds_write_b128 v252, v[20:23] offset:1024
    ds_write_b128 v252, v[60:63] offset:6144
    ds_write_b128 v252, v[24:27] offset:2048
    ds_write_b128 v252, v[64:67] offset:7168
    ds_write_b128 v252, v[28:31] offset:3072
    ds_write_b128 v252, v[68:71] offset:8192
    ds_write_b128 v252, v[32:35] offset:4096
    ds_write_b128 v252, v[72:75] offset:9216
    s_lshl_b32 s38, s35, 2
    s_add_u32 s38, s38, 161216
    v_mov_b32 v4, s38
    v_mov_b32 v5, 1
    s_mov_b64 exec, 1
    ds_add_u32 v4, v5
    s_mov_b64 exec, -1
    s_waitcnt lgkmcnt(0)
L_kf_kernel_end:
    s_endpgm
L_kf_kernel_codeend:
.section .rodata,"a"
.p2align 6
.amdhsa_kernel kf_kernel
  .amdhsa_next_free_vgpr 256
  .amdhsa_next_free_sgpr 102
  .amdhsa_accum_offset 256
  .amdhsa_group_segment_fixed_size 0
  .amdhsa_kernarg_size 136
  .amdhsa_user_sgpr_count 2
  .amdhsa_user_sgpr_kernarg_segment_ptr 1
  .amdhsa_system_sgpr_workgroup_id_x 1
.end_amdhsa_kernel
.text
```
